```python
import torch

def _softmax(x, axis=-1):
    return torch.softmax(x, dim=axis)
def _gelu(x):
    return torch.nn.functional.gelu(x, approximate="tanh")
def _silu(x):
    return torch.nn.functional.silu(x)
def _sigmoid(x):
    return torch.sigmoid(x)
def _layernorm(x, axis=-1, eps=1e-5):
    m = x.mean(dim=axis, keepdim=True)
    v = x.var(dim=axis, keepdim=True, unbiased=False)
    return (x - m) / torch.sqrt(v + eps)
def _scatter_add(tgt, idx, src, axis=0):
    return tgt.clone().index_add_(axis, idx, src)
def _segment_sum(src, seg, n):
    out = torch.zeros((n,) + src.shape[1:], dtype=src.dtype)
    return out.index_add_(0, seg, src)
def _pad(x, pw):
    flat = tuple(v for pair in reversed(pw) for v in pair)
    return torch.nn.functional.pad(x, flat)

kernel_name = 'parallel_sum__ssm_conv_s4__moe_arch_mod__prompt'

def setup_inputs():

    _w = (lambda a: (lambda t: t.to(torch.bfloat16) if t.is_floating_point() else t)(torch.as_tensor(a)))
    def _A_setup():
        B, L, D, N = 1, 2048, 512, 128
        A_re = -(lambda _x: torch.exp(torch.as_tensor(_x)))((lambda *s: torch.randn(*s, dtype=torch.bfloat16) * 3.2)(D, N))
        A_im = torch.pi * (lambda *s: torch.randn(*s, dtype=torch.bfloat16) * 0.1)(D, N)
        B_re = (lambda *s: torch.randn(*s, dtype=torch.bfloat16) * 0.4)(D, N)
        B_im = (lambda *s: torch.randn(*s, dtype=torch.bfloat16) * 0.4)(D, N)
        C_re = (lambda *s: torch.randn(*s, dtype=torch.bfloat16) * 0.4)(D, N)
        C_im = (lambda *s: torch.randn(*s, dtype=torch.bfloat16) * 0.4)(D, N)
        log_dt = (lambda *s: torch.randn(*s, dtype=torch.bfloat16) * 0.1)(D) * 0.5 - 4.0
        Dskip = (lambda *s: torch.randn(*s, dtype=torch.bfloat16) * 0.1)(D)
        return {
            "u": _w((lambda *s: torch.randn(*s, dtype=torch.bfloat16) * 0.05)(B, L, D)),
            "A_re": _w(A_re),
            "A_im": _w(A_im),
            "B_re": _w(B_re),
            "B_im": _w(B_im),
            "C_re": _w(C_re),
            "C_im": _w(C_im),
            "log_dt": _w(log_dt),
            "Dskip": _w(Dskip),
        }
    _A_in = _A_setup()

    def _B_setup():
        B, S, D, F, C = 1, 2048, 512, 1792, 1
        return {
            "x": _w((lambda *s: torch.randn(*s, dtype=torch.bfloat16) * 0.05)(B, S, D)),
            "w_r": _w((lambda *s: torch.randn(*s, dtype=torch.bfloat16) * 0.05)(D)),
            "w_gate": _w((lambda *s: torch.randn(*s, dtype=torch.bfloat16) * 0.05)(D, F)),
            "w_up": _w((lambda *s: torch.randn(*s, dtype=torch.bfloat16) * 0.05)(D, F)),
            "w_down": _w((lambda *s: torch.randn(*s, dtype=torch.bfloat16) * 0.05)(F, D)),
        }
    _B_in = _B_setup()

    return {
        "A_u": _A_in["u"],
        "A_A_re": _A_in["A_re"],
        "A_A_im": _A_in["A_im"],
        "A_B_re": _A_in["B_re"],
        "A_B_im": _A_in["B_im"],
        "A_C_re": _A_in["C_re"],
        "A_C_im": _A_in["C_im"],
        "A_log_dt": _A_in["log_dt"],
        "A_Dskip": _A_in["Dskip"],
        "B_x": _B_in["x"],
        "B_w_r": _B_in["w_r"],
        "B_w_gate": _B_in["w_gate"],
        "B_w_up": _B_in["w_up"],
        "B_w_down": _B_in["w_down"],
    }

def reference(A_u, A_A_re, A_A_im, A_B_re, A_B_im, A_C_re, A_C_im, A_log_dt, A_Dskip, B_x, B_w_r, B_w_gate, B_w_up, B_w_down):
    def _A_ref(u, A_re, A_im, B_re, B_im, C_re, C_im, log_dt, Dskip):
        Bsz, L, D = u.shape
        dt = torch.exp(log_dt)[:, None]
        A = A_re + 1j * A_im
        Bc = B_re + 1j * B_im
        Cc = C_re + 1j * C_im
        logdA = dt * A
        dB = dt * Bc
        l = (lambda x, dt: x.to(dt))(torch.arange(L), A_re.dtype)
        P = torch.exp(logdA[:, :, None] * l[None, None, :])
        K = torch.einsum("dn,dnl,dn->dl", Cc, P, dB).real
        L2 = 2 * L
        Kp = _pad(K, ((0, 0), (0, L)))
        up = (lambda x, *d: x.permute(*d))(u, 0, 2, 1)
        up = _pad(up, ((0, 0), (0, 0), (0, L)))
        Kf = (lambda x, axes=(-2,-1): torch.fft.rfft2(x.float(), dim=axes))(Kp[:, None, :], axes=(-2, -1))
        Uf = (lambda x, axes=(-2,-1): torch.fft.rfft2(x.float(), dim=axes))(up[:, :, None, :], axes=(-2, -1))
        Yf = Uf * Kf[None, :, :, :]
        y = (lambda x, s, axes=(-2,-1): torch.fft.irfft2(x, s=s, dim=axes).to(torch.bfloat16))(Yf, (1, L2), axes=(-2, -1))[:, :, 0, :L]
        y = (lambda x, *d: x.permute(*d))(y, 0, 2, 1) + u * Dskip[None, None, :]
        return y

    def _B_ref(x, w_r, w_gate, w_up, w_down):
        B, S, D = x.shape
        C = 1
        r = x @ w_r
        idx = torch.argsort(-r, axis=-1)[:, :C]
        idx_e = (lambda x, n, axis: torch.repeat_interleave(x, n, dim=axis))(idx.reshape(B, C, 1), D, axis=2)
        x_sel = (lambda x, i, axis: torch.take_along_dim(x, i, dim=axis))(x, idx_e, axis=1)
        g = _silu(x_sel @ w_gate)
        u = x_sel @ w_up
        y = (g * u) @ w_down
        r_sel = _sigmoid((lambda x, i, axis: torch.take_along_dim(x, i, dim=axis))(r, idx, axis=1))
        y = y * r_sel.reshape(B, C, 1)
        b_off = (torch.arange(B) * S).reshape(B, 1)
        flat_idx = (idx + b_off).reshape(B * C)
        zero = (x * 0.0).reshape(B * S, D)
        upd = _scatter_add(zero, flat_idx, y.reshape(B * C, D), axis=0)
        return x + upd.reshape(B, S, D)

    x = A_u
    xn = _layernorm(x, axis=-1)
    return x + _A_ref(xn, A_A_re, A_A_im, A_B_re, A_B_im, A_C_re, A_C_im, A_log_dt, A_Dskip) + _B_ref(xn, B_w_r, B_w_gate, B_w_up, B_w_down)
```

```asm
; @launch grid=(256,1,1) block=(640,1,1) lds=118656
.amdgcn_target "amdgcn-amd-amdhsa--gfx950"
.text
.globl parallel_sum__ssm_conv_s4__moe_arch_mod__prompt_kernel
.p2align 8
.type parallel_sum__ssm_conv_s4__moe_arch_mod__prompt_kernel,@function
parallel_sum__ssm_conv_s4__moe_arch_mod__prompt_kernel:
    s_getpc_b64 s[42:43]
    s_load_dwordx16 s[8:23], s[0:1], 0
    s_load_dwordx16 s[24:39], s[0:1], 64
    s_load_dwordx2 s[40:41], s[0:1], 128
    s_cmpk_gt_u32 s2, 255
    s_cbranch_scc1 L_exit
    v_lshrrev_b32 v2, 6, v0
    v_and_b32 v1, 63, v0
    s_lshr_b32 s50, s2, 3
    v_readfirstlane_b32 s4, v2
    s_and_b32 s51, s2, 7
    s_and_b32 s7, s50, 7
    s_lshl_b32 s7, s7, 3
    s_add_u32 s7, s7, s4
    s_mulk_i32 s7, 384
    v_min_u32 v2, 2, v1
    v_lshl_add_u32 v2, v2, 7, s7
    v_min_u32 v2, L_end-parallel_sum__ssm_conv_s4__moe_arch_mod__prompt_kernel-8, v2
    global_load_dword v159, v2, s[42:43]
    s_lshl_b32 s3, s51, 5
    s_add_u32 s3, s3, s50
    v_mov_b32 v160, 118336
    s_cmp_ge_u32 s4, 8
    s_cbranch_scc1 L_special
    s_lshl_b32 s7, s2, 13
    v_lshl_add_u32 v18, v0, 4, s7
    v_lshlrev_b32 v17, 4, v1
    s_and_b32 s43, s4, 1
    s_lshl_b32 s7, s3, 9
    s_lshl_b32 s51, s43, 8
    s_bfe_u32 s50, s4, 0x10001
    s_add_u32 s7, s7, s51
    s_lshl_b32 s51, s50, 7
    s_add_u32 s7, s7, s51
    v_lshl_add_u32 v19, v1, 1, s7
    v_mov_b32 v10, 0
    v_mov_b32 v11, 0
    v_mov_b32 v12, 0
    v_mov_b32 v13, 0
    v_mov_b32 v14, 0
    v_mov_b32 v15, 0
    s_lshl_b32 s7, s3, 2
    s_waitcnt lgkmcnt(0)
    global_load_dwordx4 v[2:5], v18, s[8:9] nt
    global_load_dwordx4 v[6:9], v17, s[28:29]
    s_load_dword s6, s[40:41], 0
    s_load_dword s48, s[22:23], s7
    s_load_dword s49, s[24:25], s7
    s_barrier
    global_load_short_d16_hi v10, v19, s[10:11] nt
    global_load_short_d16_hi v11, v19, s[12:13] nt
    s_cmp_ge_u32 s4, 4
    s_cbranch_scc1 L_ln
    global_load_short_d16_hi v12, v19, s[14:15] nt
    global_load_short_d16_hi v13, v19, s[16:17] nt
    global_load_short_d16_hi v14, v19, s[18:19] nt
    global_load_short_d16_hi v15, v19, s[20:21] nt
    s_branch L_ln
L_special:
    s_cmp_eq_u32 s4, 8
    s_cbranch_scc1 L_moe0
    s_lshl_b32 s7, s50, 16
    s_lshl_b32 s53, s51, 7
    s_add_u32 s7, s7, s53
    v_and_b32 v6, 7, v1
    v_lshrrev_b32 v7, 3, v1
    v_lshl_add_u32 v4, v7, 4, s7
    v_lshl_add_u32 v4, v6, 13, v4
    v_add_u32 v5, 4096, v4
    s_waitcnt lgkmcnt(0)
    global_load_dwordx4 v[64:67], v4, s[8:9] offset:0 nt
    global_load_dwordx4 v[68:71], v4, s[8:9] offset:1024 nt
    global_load_dwordx4 v[72:75], v4, s[8:9] offset:2048 nt
    global_load_dwordx4 v[76:79], v4, s[8:9] offset:3072 nt
    global_load_dwordx4 v[80:83], v5, s[8:9] offset:0 nt
    global_load_dwordx4 v[84:87], v5, s[8:9] offset:1024 nt
    global_load_dwordx4 v[88:91], v5, s[8:9] offset:2048 nt
    global_load_dwordx4 v[92:95], v5, s[8:9] offset:3072 nt
    s_load_dword s6, s[40:41], 0
    s_barrier
    s_branch L_tr
L_moe0:
    v_mov_b32 v8, 0
    v_lshl_add_u32 v6, v1, 2, v160
    ds_write_b32 v6, v8
    s_waitcnt lgkmcnt(0)
    s_load_dword s6, s[40:41], 0
    s_barrier
    s_branch L_moe
L_ln:
    s_mov_b32 s88, 0x400000
    s_lshl_b32 s42, s2, 3
    s_add_u32 s42, s42, s4
    s_mov_b32 s52, 0xffff0000
    s_mul_i32 s7, s43, 33792
    s_lshl_b32 s51, s50, 8
    s_add_u32 s7, s7, s51
    v_lshl_add_u32 v62, v1, 2, s7
    s_waitcnt lgkmcnt(0)
    s_mul_i32 s5, s6, 0x9E3779B1
    s_add_u32 s5, s5, 0x7F4A7C15
    s_lshl_b32 s7, s48, 16
    s_and_b32 s51, s48, s52
    s_cmp_eq_u32 s43, 0
    s_cselect_b32 s7, s7, s51
    v_mov_b32 v20, s7
    v_mul_f32 v21, 0x3fb8aa3b, v20
    v_mov_b32 v22, 0x3fb8aa3b
    v_fma_f32 v22, v20, v22, -v21
    v_fmac_f32 v22, 0x32a57060, v20
    v_exp_f32 v21, v21
    v_mul_f32 v22, 0x3f317218, v22
    v_fmac_f32 v21, v21, v22
    v_cvt_pk_bf16_f32 v21, v21, v21
    v_and_b32 v16, s52, v21
    v_mov_b32 v44, 0
    v_mov_b32 v45, 0
    v_mov_b32 v46, 0x3f803f80
    v_mov_b32 v47, 0x3b000000
    s_sub_u32 s47, 2047, s42
    v_mov_b32 v43, s47
    s_lshl_b32 s7, s4, 2
    s_add_u32 s7, s7, 118272
    v_mov_b32 v48, s7
    v_mov_b32 v49, 1
    s_cmp_ge_u32 s4, 4
    s_cbranch_scc1 L_addr_io
    s_cmp_eq_u32 s50, 0
    s_mov_b32 s54, 0x7777fe01
    s_mov_b32 s55, 0x77777777
    s_cmov_b32 s54, 0x76543210
    s_cmov_b32 s55, 0xccccba98
    s_mov_b32 s56, 0x4444eb70
    s_mov_b32 s57, 0x44444444
    s_cmov_b32 s56, 0x7a000166
    s_cmov_b32 s57, 0x5555ce77
    s_cselect_b32 s58, 0, 15
    s_cselect_b32 s59, 13, 17
    v_and_b32 v20, 31, v1
    v_and_b32 v21, 4, v20
    v_cmp_ne_u32 vcc, 0, v21
    v_and_b32 v21, 3, v20
    v_lshrrev_b32 v22, 3, v20
    v_lshl_add_u32 v21, v22, 2, v21
    v_lshlrev_b32 v21, 2, v21
    v_mov_b32 v22, s54
    v_mov_b32 v23, s55
    v_mov_b32 v24, s56
    v_mov_b32 v25, s57
    v_mov_b32 v26, s58
    v_mov_b32 v27, s59
    v_cndmask_b32 v22, v22, v24, vcc
    v_cndmask_b32 v23, v23, v25, vcc
    v_cndmask_b32 v26, v26, v27, vcc
    v_lshrrev_b64 v[22:23], v21, v[22:23]
    v_and_b32 v22, 15, v22
    v_add_u32 v22, v22, v26
    s_mul_i32 s7, s43, 33792
    v_lshrrev_b32 v23, 5, v1
    v_lshl_add_u32 v23, v23, 4, s7
    s_movk_i32 s51, 528
    v_mad_u32_u24 v141, v22, s51, v23
    v_mad_u32_u24 v142, v20, s51, v23
    v_and_b32 v20, 15, v1
    v_lshrrev_b32 v21, 4, v1
    v_add_u32 v22, 1, v20
    v_and_b32 v23, 3, v22
    v_lshrrev_b32 v22, 2, v22
    s_mul_i32 s7, s43, 16640
    s_add_u32 s7, s7, 67584
    s_movk_i32 s51, 4160
    v_mov_b32 v143, s7
    v_mad_u32_u24 v143, v23, s51, v143
    v_lshl_add_u32 v143, v22, 3, v143
    v_lshl_add_u32 v143, v21, 4, v143
    s_mul_i32 s51, s43, 4608
    s_add_u32 s51, s51, 100944
    v_lshlrev_b32 v22, 1, v20
    v_sub_u32 v22, v22, v21
    v_lshl_add_u32 v144, v22, 4, s51
    s_mul_i32 s51, s43, 4096
    s_add_u32 s51, s51, 110080
    v_lshl_add_u32 v145, v20, 5, s51
    v_lshl_add_u32 v145, v21, 3, v145
    s_lshl_b32 s51, s50, 10
    s_add_u32 s7, s7, s51
    s_add_u32 s7, s7, 32
    v_lshl_add_u32 v146, v1, 4, s7
    v_mov_b32 v24, 0
    v_mov_b32 v25, 0
    v_mov_b32 v26, 0
    v_mov_b32 v27, 0
    v_min_u32 v22, 7, v1
    v_lshrrev_b32 v23, 1, v22
    v_and_b32 v22, 1, v22
    v_mul_u32_u24 v23, 4160, v23
    v_lshl_add_u32 v22, v22, 4, v23
    s_mul_i32 s7, s43, 16640
    s_add_u32 s7, s7, 67584
    v_add_u32 v22, s7, v22
    s_cmp_eq_u32 s50, 0
    s_cbranch_scc0 L_no_head
    ds_write_b128 v22, v[24:27]
L_no_head:
    s_branch L_addr_done
L_addr_io:
    v_and_b32 v136, 255, v0
    v_lshlrev_b32 v137, 4, v136
    v_add_u32 v137, 8192, v137
    v_add_u32 v140, 4096, v137
    s_mul_i32 s7, s3, 12288
    s_add_u32 s7, s7, 524288
    v_lshrrev_b32 v138, 3, v136
    v_mul_u32_u24 v138, 384, v138
    v_and_b32 v139, 7, v136
    v_lshl_add_u32 v138, v139, 4, v138
    v_add_u32 v138, s7, v138
    v_lshlrev_b32 v139, 4, v136
    v_add_u32 v139, 101376, v139
    v_mov_b32 v24, 0
    v_mov_b32 v25, 0
    v_mov_b32 v26, 0
    v_mov_b32 v27, 0
    v_and_b32 v22, 31, v1
    v_lshrrev_b32 v23, 5, v1
    v_mul_u32_u24 v23, 4608, v23
    v_lshl_add_u32 v22, v22, 4, v23
    v_add_u32 v22, 100864, v22
    ds_write_b128 v22, v[24:27]
L_addr_done:
    s_setprio 2
    s_cmp_ge_u32 s4, 4
    s_cbranch_scc1 L_wait_io
    s_waitcnt vmcnt(6)
L_wait_io:
    s_cbranch_scc0 L_wait_done
    s_waitcnt vmcnt(2)
L_wait_done:
    v_lshlrev_b32 v20, 16, v2
    v_and_b32 v21, s52, v2
    v_readfirstlane_b32 s44, v20
    v_lshlrev_b32 v22, 16, v3
    v_and_b32 v23, s52, v3
    v_lshlrev_b32 v24, 16, v4
    v_and_b32 v25, s52, v4
    v_lshlrev_b32 v26, 16, v5
    v_and_b32 v27, s52, v5
    v_pk_add_f32 v[28:29], v[20:21], s[44:45] op_sel_hi:[1,0] neg_lo:[0,1] neg_hi:[0,1]
    v_dot2_f32_bf16 v44, v2, v6, v44
    v_dot2_f32_bf16 v45, v46, v6, v45
    v_pk_add_f32 v[30:31], v[22:23], s[44:45] op_sel_hi:[1,0] neg_lo:[0,1] neg_hi:[0,1]
    v_dot2_f32_bf16 v44, v3, v7, v44
    v_dot2_f32_bf16 v45, v46, v7, v45
    v_pk_add_f32 v[32:33], v[24:25], s[44:45] op_sel_hi:[1,0] neg_lo:[0,1] neg_hi:[0,1]
    v_dot2_f32_bf16 v44, v4, v8, v44
    v_dot2_f32_bf16 v45, v46, v8, v45
    v_pk_add_f32 v[34:35], v[26:27], s[44:45] op_sel_hi:[1,0] neg_lo:[0,1] neg_hi:[0,1]
    v_dot2_f32_bf16 v44, v5, v9, v44
    v_dot2_f32_bf16 v45, v46, v9, v45
    v_pk_add_f32 v[36:37], v[28:29], v[30:31]
    v_pk_mul_f32 v[40:41], v[28:29], v[28:29]
    v_pk_add_f32 v[38:39], v[32:33], v[34:35]
    v_pk_fma_f32 v[40:41], v[30:31], v[30:31], v[40:41]
    v_pk_add_f32 v[36:37], v[36:37], v[38:39]
    v_pk_fma_f32 v[40:41], v[32:33], v[32:33], v[40:41]
    v_add_f32 v36, v36, v37
    v_pk_fma_f32 v[40:41], v[34:35], v[34:35], v[40:41]
    v_add_f32 v40, v40, v41
    v_add_f32_dpp v44, v44, v44 row_shr:1 row_mask:0xf bank_mask:0xf
    v_add_f32_dpp v45, v45, v45 row_shr:1 row_mask:0xf bank_mask:0xf
    v_add_f32_dpp v36, v36, v36 row_shr:1 row_mask:0xf bank_mask:0xf
    v_add_f32_dpp v40, v40, v40 row_shr:1 row_mask:0xf bank_mask:0xf
    v_add_f32_dpp v44, v44, v44 row_shr:2 row_mask:0xf bank_mask:0xf
    v_add_f32_dpp v45, v45, v45 row_shr:2 row_mask:0xf bank_mask:0xf
    v_add_f32_dpp v36, v36, v36 row_shr:2 row_mask:0xf bank_mask:0xf
    v_add_f32_dpp v40, v40, v40 row_shr:2 row_mask:0xf bank_mask:0xf
    v_add_f32_dpp v44, v44, v44 row_shr:4 row_mask:0xf bank_mask:0xf
    v_add_f32_dpp v45, v45, v45 row_shr:4 row_mask:0xf bank_mask:0xf
    v_add_f32_dpp v36, v36, v36 row_shr:4 row_mask:0xf bank_mask:0xf
    v_add_f32_dpp v40, v40, v40 row_shr:4 row_mask:0xf bank_mask:0xf
    v_add_f32_dpp v44, v44, v44 row_shr:8 row_mask:0xf bank_mask:0xf
    v_add_f32_dpp v45, v45, v45 row_shr:8 row_mask:0xf bank_mask:0xf
    v_add_f32_dpp v36, v36, v36 row_shr:8 row_mask:0xf bank_mask:0xf
    v_add_f32_dpp v40, v40, v40 row_shr:8 row_mask:0xf bank_mask:0xf
    v_add_f32_dpp v44, v44, v44 row_bcast:15 row_mask:0xa bank_mask:0xf
    v_add_f32_dpp v45, v45, v45 row_bcast:15 row_mask:0xa bank_mask:0xf
    v_add_f32_dpp v36, v36, v36 row_bcast:15 row_mask:0xa bank_mask:0xf
    v_add_f32_dpp v40, v40, v40 row_bcast:15 row_mask:0xa bank_mask:0xf
    v_add_f32_dpp v44, v44, v44 row_bcast:31 row_mask:0xc bank_mask:0xf
    v_add_f32_dpp v45, v45, v45 row_bcast:31 row_mask:0xc bank_mask:0xf
    v_add_f32_dpp v36, v36, v36 row_bcast:31 row_mask:0xc bank_mask:0xf
    v_add_f32_dpp v40, v40, v40 row_bcast:31 row_mask:0xc bank_mask:0xf
    v_mul_f32 v36, v36, v47
    v_mul_f32 v40, v40, v47
    v_fma_f32 v40, -v36, v36, v40
    v_add_f32 v36, s44, v36
    v_max_f32 v40, 0, v40
    v_cvt_pk_bf16_f32 v41, v36, v40
    v_and_b32 v40, s52, v41
    v_lshlrev_b32 v36, 16, v41
    v_add_f32 v40, 0x3727c5ac, v40
    v_fma_f32 v44, -v36, v45, v44
    v_cvt_pk_bf16_f32 v40, v40, v40
    v_and_b32 v40, s52, v40
    v_sqrt_f32 v40, v40
    s_nop 0
    v_cvt_pk_bf16_f32 v40, v40, v40
    v_and_b32 v40, s52, v40
    v_rcp_f32 v38, v40
    v_bfi_b32 v42, s52, v40, v41
    v_mul_f32 v36, v44, v38
    v_cvt_pk_bf16_f32 v36, v36, v36
    v_ashrrev_i32 v37, 31, v36
    v_or_b32 v37, 0x80000000, v37
    v_xor_b32 v36, v36, v37
    v_bfi_b32 v43, s52, v36, v43
    s_mov_b32 exec_lo, 0
    s_mov_b32 exec_hi, 0x80000000
    ds_write_b32 v48, v42
    ds_max_u64 v160, v[42:43] offset:24
    ds_add_u32 v160, v49 offset:16
    s_mov_b64 exec, -1
    s_setprio 0
    s_waitcnt vmcnt(0)
    v_mul_f32 v10, v16, v10
    v_mul_f32 v11, v16, v11
    v_mul_f32 v10, 0x3fb8aa3b, v10
    v_mul_f32 v11, 0x3e22f983, v11
    s_cmp_ge_u32 s4, 4
    s_cbranch_scc0 L_hi
    s_setprio 1
    s_branch L_io
L_hi:
    v_mul_f32 v40, 0x3f800000, v10
    v_mul_f32 v41, 0x3f800000, v11
    v_mul_f32 v42, 0x43800000, v10
    v_mul_f32 v43, 0x43800000, v11
    v_mul_f32 v44, 0x41000000, v10
    v_mul_f32 v45, 0x41000000, v11
    v_exp_f32 v40, v40
    v_fract_f32 v41, v41
    v_exp_f32 v42, v42
    v_fract_f32 v43, v43
    v_exp_f32 v44, v44
    v_fract_f32 v45, v45
    v_cos_f32 v20, v41
    v_sin_f32 v21, v41
    v_cos_f32 v28, v43
    v_sin_f32 v29, v43
    v_cos_f32 v26, v45
    v_sin_f32 v27, v45
    v_pk_mul_f32 v[20:21], v[20:21], v[40:41] op_sel:[0,0] op_sel_hi:[1,0]
    v_pk_mul_f32 v[28:29], v[28:29], v[42:43] op_sel:[0,0] op_sel_hi:[1,0]
    v_pk_mul_f32 v[26:27], v[26:27], v[44:45] op_sel:[0,0] op_sel_hi:[1,0]
    v_pk_mul_f32 v[12:13], v[12:13], v[16:17] op_sel_hi:[1,0]
    v_pk_mul_f32 v[40:41], v[14:15], v[12:13] op_sel:[0,0] op_sel_hi:[0,1]
    v_pk_mul_f32 v[42:43], v[20:21], v[20:21] op_sel:[0,0] op_sel_hi:[0,1]
    v_pk_fma_f32 v[30:31], v[14:15], v[12:13], v[40:41] op_sel:[1,1,0] op_sel_hi:[1,0,1] neg_lo:[1,0,0]
    v_pk_fma_f32 v[22:23], v[20:21], v[20:21], v[42:43] op_sel:[1,1,0] op_sel_hi:[1,0,1] neg_lo:[1,0,0]
    v_pk_mul_f32 v[40:41], v[30:31], v[20:21] op_sel:[0,0] op_sel_hi:[0,1]
    v_pk_mul_f32 v[42:43], v[30:31], v[28:29] op_sel:[0,0] op_sel_hi:[0,1]
    v_pk_mul_f32 v[44:45], v[22:23], v[22:23] op_sel:[0,0] op_sel_hi:[0,1]
    v_pk_fma_f32 v[34:35], v[30:31], v[20:21], v[40:41] op_sel:[1,1,0] op_sel_hi:[1,0,1] neg_lo:[1,0,0]
    v_pk_fma_f32 v[36:37], v[30:31], v[28:29], v[42:43] op_sel:[1,1,0] op_sel_hi:[1,0,1] neg_lo:[1,0,0]
    v_pk_fma_f32 v[24:25], v[22:23], v[22:23], v[44:45] op_sel:[1,1,0] op_sel_hi:[1,0,1] neg_lo:[1,0,0]
    v_cvt_pk_bf16_f32 v50, v30, -v31
    ds_write_b32 v62, v50 offset:0
    v_cvt_pk_bf16_f32 v51, v34, -v35
    ds_write_b32 v62, v51 offset:528
    v_cvt_pk_bf16_f32 v52, v36, -v37
    ds_write_b32 v62, v52 offset:10032
    v_pk_mul_f32 v[40:41], v[30:31], v[22:23] op_sel:[0,0] op_sel_hi:[0,1]
    v_pk_mul_f32 v[42:43], v[34:35], v[22:23] op_sel:[0,0] op_sel_hi:[0,1]
    v_pk_mul_f32 v[44:45], v[36:37], v[22:23] op_sel:[0,0] op_sel_hi:[0,1]
    v_pk_mul_f32 v[46:47], v[36:37], v[28:29] op_sel:[0,0] op_sel_hi:[0,1]
    v_pk_fma_f32 v[32:33], v[30:31], v[22:23], v[40:41] op_sel:[1,1,0] op_sel_hi:[1,0,1] neg_lo:[1,0,0]
    v_pk_fma_f32 v[34:35], v[34:35], v[22:23], v[42:43] op_sel:[1,1,0] op_sel_hi:[1,0,1] neg_lo:[1,0,0]
    v_pk_fma_f32 v[38:39], v[36:37], v[22:23], v[44:45] op_sel:[1,1,0] op_sel_hi:[1,0,1] neg_lo:[1,0,0]
    v_pk_fma_f32 v[54:55], v[36:37], v[28:29], v[46:47] op_sel:[1,1,0] op_sel_hi:[1,0,1] neg_lo:[1,0,0]
    v_cvt_pk_bf16_f32 v50, v32, -v33
    ds_write_b32 v62, v50 offset:1056
    v_cvt_pk_bf16_f32 v51, v34, -v35
    ds_write_b32 v62, v51 offset:1584
    v_cvt_pk_bf16_f32 v52, v38, -v39
    ds_write_b32 v62, v52 offset:7392
    v_cvt_pk_bf16_f32 v53, v54, -v55
    ds_write_b32 v62, v53 offset:8448
    v_pk_mul_f32 v[40:41], v[32:33], v[22:23] op_sel:[0,0] op_sel_hi:[0,1]
    v_pk_mul_f32 v[42:43], v[34:35], v[22:23] op_sel:[0,0] op_sel_hi:[0,1]
    v_pk_mul_f32 v[44:45], v[38:39], v[22:23] op_sel:[0,0] op_sel_hi:[0,1]
    v_pk_mul_f32 v[46:47], v[54:55], v[28:29] op_sel:[0,0] op_sel_hi:[0,1]
    v_pk_fma_f32 v[32:33], v[32:33], v[22:23], v[40:41] op_sel:[1,1,0] op_sel_hi:[1,0,1] neg_lo:[1,0,0]
    v_pk_fma_f32 v[34:35], v[34:35], v[22:23], v[42:43] op_sel:[1,1,0] op_sel_hi:[1,0,1] neg_lo:[1,0,0]
    v_pk_fma_f32 v[38:39], v[38:39], v[22:23], v[44:45] op_sel:[1,1,0] op_sel_hi:[1,0,1] neg_lo:[1,0,0]
    v_pk_fma_f32 v[56:57], v[54:55], v[28:29], v[46:47] op_sel:[1,1,0] op_sel_hi:[1,0,1] neg_lo:[1,0,0]
    v_cvt_pk_bf16_f32 v50, v32, -v33
    ds_write_b32 v62, v50 offset:2112
    v_cvt_pk_bf16_f32 v51, v34, -v35
    ds_write_b32 v62, v51 offset:2640
    v_cvt_pk_bf16_f32 v52, v38, -v39
    ds_write_b32 v62, v52 offset:6864
    v_cvt_pk_bf16_f32 v53, v56, -v57
    ds_write_b32 v62, v53 offset:8976
    v_pk_mul_f32 v[40:41], v[32:33], v[22:23] op_sel:[0,0] op_sel_hi:[0,1]
    v_pk_mul_f32 v[42:43], v[34:35], v[22:23] op_sel:[0,0] op_sel_hi:[0,1]
    v_pk_mul_f32 v[44:45], v[38:39], v[22:23] op_sel:[0,0] op_sel_hi:[0,1]
    v_pk_mul_f32 v[46:47], v[56:57], v[28:29] op_sel:[0,0] op_sel_hi:[0,1]
    v_pk_fma_f32 v[32:33], v[32:33], v[22:23], v[40:41] op_sel:[1,1,0] op_sel_hi:[1,0,1] neg_lo:[1,0,0]
    v_pk_fma_f32 v[34:35], v[34:35], v[22:23], v[42:43] op_sel:[1,1,0] op_sel_hi:[1,0,1] neg_lo:[1,0,0]
    v_pk_fma_f32 v[38:39], v[38:39], v[22:23], v[44:45] op_sel:[1,1,0] op_sel_hi:[1,0,1] neg_lo:[1,0,0]
    v_pk_fma_f32 v[58:59], v[56:57], v[28:29], v[46:47] op_sel:[1,1,0] op_sel_hi:[1,0,1] neg_lo:[1,0,0]
    v_cvt_pk_bf16_f32 v50, v32, -v33
    ds_write_b32 v62, v50 offset:3168
    v_cvt_pk_bf16_f32 v51, v34, -v35
    ds_write_b32 v62, v51 offset:3696
    v_cvt_pk_bf16_f32 v52, v38, -v39
    ds_write_b32 v62, v52 offset:12144
    v_cvt_pk_bf16_f32 v53, v58, -v59
    ds_write_b32 v62, v53 offset:5808
    v_pk_mul_f32 v[40:41], v[32:33], v[22:23] op_sel:[0,0] op_sel_hi:[0,1]
    v_pk_mul_f32 v[42:43], v[34:35], v[22:23] op_sel:[0,0] op_sel_hi:[0,1]
    v_pk_mul_f32 v[44:45], v[38:39], v[22:23] op_sel:[0,0] op_sel_hi:[0,1]
    v_pk_mul_f32 v[46:47], v[58:59], v[28:29] op_sel:[0,0] op_sel_hi:[0,1]
    v_pk_fma_f32 v[32:33], v[32:33], v[22:23], v[40:41] op_sel:[1,1,0] op_sel_hi:[1,0,1] neg_lo:[1,0,0]
    v_pk_fma_f32 v[34:35], v[34:35], v[22:23], v[42:43] op_sel:[1,1,0] op_sel_hi:[1,0,1] neg_lo:[1,0,0]
    v_pk_fma_f32 v[38:39], v[38:39], v[22:23], v[44:45] op_sel:[1,1,0] op_sel_hi:[1,0,1] neg_lo:[1,0,0]
    v_pk_fma_f32 v[60:61], v[58:59], v[28:29], v[46:47] op_sel:[1,1,0] op_sel_hi:[1,0,1] neg_lo:[1,0,0]
    v_cvt_pk_bf16_f32 v50, v32, -v33
    ds_write_b32 v62, v50 offset:4224
    v_cvt_pk_bf16_f32 v51, v34, -v35
    ds_write_b32 v62, v51 offset:4752
    v_cvt_pk_bf16_f32 v52, v38, -v39
    ds_write_b32 v62, v52 offset:10560
    v_cvt_pk_bf16_f32 v53, v60, -v61
    ds_write_b32 v62, v53 offset:13200
    v_pk_mul_f32 v[40:41], v[32:33], v[22:23] op_sel:[0,0] op_sel_hi:[0,1]
    v_pk_mul_f32 v[44:45], v[38:39], v[22:23] op_sel:[0,0] op_sel_hi:[0,1]
    v_pk_mul_f32 v[46:47], v[60:61], v[28:29] op_sel:[0,0] op_sel_hi:[0,1]
    v_pk_fma_f32 v[32:33], v[32:33], v[22:23], v[40:41] op_sel:[1,1,0] op_sel_hi:[1,0,1] neg_lo:[1,0,0]
    v_pk_fma_f32 v[38:39], v[38:39], v[22:23], v[44:45] op_sel:[1,1,0] op_sel_hi:[1,0,1] neg_lo:[1,0,0]
    v_pk_fma_f32 v[64:65], v[60:61], v[28:29], v[46:47] op_sel:[1,1,0] op_sel_hi:[1,0,1] neg_lo:[1,0,0]
    v_cvt_pk_bf16_f32 v50, v32, -v33
    ds_write_b32 v62, v50 offset:5280
    v_cvt_pk_bf16_f32 v52, v38, -v39
    ds_write_b32 v62, v52 offset:14256
    v_cvt_pk_bf16_f32 v53, v64, -v65
    ds_write_b32 v62, v53 offset:15840
    v_pk_mul_f32 v[40:41], v[64:65], v[28:29] op_sel:[0,0] op_sel_hi:[0,1]
    v_pk_mul_f32 v[42:43], v[54:55], v[24:25] op_sel:[0,0] op_sel_hi:[0,1]
    v_pk_mul_f32 v[44:45], v[56:57], v[24:25] op_sel:[0,0] op_sel_hi:[0,1]
    v_pk_mul_f32 v[46:47], v[54:55], v[26:27] op_sel:[0,0] op_sel_hi:[0,1]
    v_pk_mul_f32 v[48:49], v[56:57], v[26:27] op_sel:[0,0] op_sel_hi:[0,1]
    v_pk_fma_f32 v[66:67], v[64:65], v[28:29], v[40:41] op_sel:[1,1,0] op_sel_hi:[1,0,1] neg_lo:[1,0,0]
    v_pk_fma_f32 v[32:33], v[54:55], v[24:25], v[42:43] op_sel:[1,1,0] op_sel_hi:[1,0,1] neg_lo:[1,0,0]
    v_pk_fma_f32 v[34:35], v[56:57], v[24:25], v[44:45] op_sel:[1,1,0] op_sel_hi:[1,0,1] neg_lo:[1,0,0]
    v_pk_fma_f32 v[54:55], v[54:55], v[26:27], v[46:47] op_sel:[1,1,0] op_sel_hi:[1,0,1] neg_lo:[1,0,0]
    v_pk_fma_f32 v[56:57], v[56:57], v[26:27], v[48:49] op_sel:[1,1,0] op_sel_hi:[1,0,1] neg_lo:[1,0,0]
    v_cvt_pk_bf16_f32 v50, v66, -v67
    ds_write_b32 v62, v50 offset:16368
    v_cvt_pk_bf16_f32 v51, v32, -v33
    ds_write_b32 v62, v51 offset:7920
    v_cvt_pk_bf16_f32 v52, v34, -v35
    ds_write_b32 v62, v52 offset:12672
    v_cvt_pk_bf16_f32 v53, v54, -v55
    ds_write_b32 v62, v53 offset:15312
    v_cvt_pk_bf16_f32 v50, v56, -v57
    ds_write_b32 v62, v50 offset:14784
    v_pk_mul_f32 v[40:41], v[58:59], v[26:27] op_sel:[0,0] op_sel_hi:[0,1]
    v_pk_mul_f32 v[42:43], v[60:61], v[26:27] op_sel:[0,0] op_sel_hi:[0,1]
    v_pk_mul_f32 v[44:45], v[64:65], v[26:27] op_sel:[0,0] op_sel_hi:[0,1]
    v_pk_mul_f32 v[46:47], v[66:67], v[26:27] op_sel:[0,0] op_sel_hi:[0,1]
    v_pk_fma_f32 v[58:59], v[58:59], v[26:27], v[40:41] op_sel:[1,1,0] op_sel_hi:[1,0,1] neg_lo:[1,0,0]
    v_pk_fma_f32 v[60:61], v[60:61], v[26:27], v[42:43] op_sel:[1,1,0] op_sel_hi:[1,0,1] neg_lo:[1,0,0]
    v_pk_fma_f32 v[64:65], v[64:65], v[26:27], v[44:45] op_sel:[1,1,0] op_sel_hi:[1,0,1] neg_lo:[1,0,0]
    v_pk_fma_f32 v[66:67], v[66:67], v[26:27], v[46:47] op_sel:[1,1,0] op_sel_hi:[1,0,1] neg_lo:[1,0,0]
    v_cvt_pk_bf16_f32 v50, v58, -v59
    ds_write_b32 v62, v50 offset:6336
    v_cvt_pk_bf16_f32 v51, v60, -v61
    ds_write_b32 v62, v51 offset:9504
    v_cvt_pk_bf16_f32 v52, v64, -v65
    ds_write_b32 v62, v52 offset:11616
    v_cvt_pk_bf16_f32 v53, v66, -v67
    ds_write_b32 v62, v53 offset:11088
    s_lshl_b32 s51, 262144, s4
    s_mov_b64 exec, 1
    v_mov_b32 v50, s51
    ds_or_b32 v160, v50
    s_mov_b64 exec, -1
    s_setprio 3
L_ws_1:
    ds_read_b32 v20, v160
    s_sub_u32 s88, s88, 1
    s_cbranch_scc1 L_exit
    s_waitcnt lgkmcnt(0)
    v_readfirstlane_b32 s7, v20
    s_and_b32 s7, s7, 66846720
    s_cmp_eq_u32 s7, 66846720
    s_cbranch_scc0 L_ws_1
    ds_read_b128 v[80:83], v141 offset:0
    ds_read_b128 v[96:99], v142 offset:16896
    ds_read_b128 v[84:87], v141 offset:32
    ds_read_b128 v[100:103], v142 offset:16928
    ds_read_b128 v[88:91], v141 offset:64
    ds_read_b128 v[104:107], v142 offset:16960
    ds_read_b128 v[92:95], v141 offset:96
    ds_read_b128 v[108:111], v142 offset:16992
    s_waitcnt lgkmcnt(6)
    v_mfma_f32_32x32x16_bf16 v[64:79], v[80:83], v[96:99], 0
    ds_read_b128 v[80:83], v141 offset:128
    ds_read_b128 v[96:99], v142 offset:17024
    s_waitcnt lgkmcnt(6)
    v_mfma_f32_32x32x16_bf16 v[64:79], v[84:87], v[100:103], v[64:79]
    ds_read_b128 v[84:87], v141 offset:160
    ds_read_b128 v[100:103], v142 offset:17056
    s_waitcnt lgkmcnt(6)
    v_mfma_f32_32x32x16_bf16 v[64:79], v[88:91], v[104:107], v[64:79]
    ds_read_b128 v[88:91], v141 offset:192
    ds_read_b128 v[104:107], v142 offset:17088
    s_waitcnt lgkmcnt(6)
    v_mfma_f32_32x32x16_bf16 v[64:79], v[92:95], v[108:111], v[64:79]
    ds_read_b128 v[92:95], v141 offset:224
    ds_read_b128 v[108:111], v142 offset:17120
    s_waitcnt lgkmcnt(6)
    v_mfma_f32_32x32x16_bf16 v[64:79], v[80:83], v[96:99], v[64:79]
    ds_read_b128 v[80:83], v141 offset:256
    ds_read_b128 v[96:99], v142 offset:17152
    s_waitcnt lgkmcnt(6)
    v_mfma_f32_32x32x16_bf16 v[64:79], v[84:87], v[100:103], v[64:79]
    ds_read_b128 v[84:87], v141 offset:288
    ds_read_b128 v[100:103], v142 offset:17184
    s_waitcnt lgkmcnt(6)
    v_mfma_f32_32x32x16_bf16 v[64:79], v[88:91], v[104:107], v[64:79]
    ds_read_b128 v[88:91], v141 offset:320
    ds_read_b128 v[104:107], v142 offset:17216
    s_waitcnt lgkmcnt(6)
    v_mfma_f32_32x32x16_bf16 v[64:79], v[92:95], v[108:111], v[64:79]
    ds_read_b128 v[92:95], v141 offset:352
    ds_read_b128 v[108:111], v142 offset:17248
    s_waitcnt lgkmcnt(6)
    v_mfma_f32_32x32x16_bf16 v[64:79], v[80:83], v[96:99], v[64:79]
    ds_read_b128 v[80:83], v141 offset:384
    ds_read_b128 v[96:99], v142 offset:17280
    s_waitcnt lgkmcnt(6)
    v_mfma_f32_32x32x16_bf16 v[64:79], v[84:87], v[100:103], v[64:79]
    ds_read_b128 v[84:87], v141 offset:416
    ds_read_b128 v[100:103], v142 offset:17312
    s_waitcnt lgkmcnt(6)
    v_mfma_f32_32x32x16_bf16 v[64:79], v[88:91], v[104:107], v[64:79]
    ds_read_b128 v[88:91], v141 offset:448
    ds_read_b128 v[104:107], v142 offset:17344
    s_waitcnt lgkmcnt(6)
    v_mfma_f32_32x32x16_bf16 v[64:79], v[92:95], v[108:111], v[64:79]
    ds_read_b128 v[92:95], v141 offset:480
    ds_read_b128 v[108:111], v142 offset:17376
    s_waitcnt lgkmcnt(6)
    v_mfma_f32_32x32x16_bf16 v[64:79], v[80:83], v[96:99], v[64:79]
    s_waitcnt lgkmcnt(4)
    v_mfma_f32_32x32x16_bf16 v[64:79], v[84:87], v[100:103], v[64:79]
    s_waitcnt lgkmcnt(2)
    v_mfma_f32_32x32x16_bf16 v[64:79], v[88:91], v[104:107], v[64:79]
    s_waitcnt lgkmcnt(0)
    v_mfma_f32_32x32x16_bf16 v[64:79], v[92:95], v[108:111], v[64:79]
    s_mov_b32 s54, 0x80000000
    s_mov_b32 s55, 0x80000000
    s_mov_b32 s56, 0
    s_mov_b32 s57, 0x80000000
    s_mov_b32 s58, 0xaaaaaaaa
    s_mov_b32 s59, 0xaaaaaaaa
    s_cmp_eq_u32 s50, 0
    s_nop 3
    s_cbranch_scc0 L_kwin_b
    s_nop 3
    v_cndmask_b32 v73, v73, v72, s[54:55]
    v_cndmask_b32 v74, v74, v72, s[56:57]
    v_cvt_pk_bf16_f32 v80, v64, v65
    v_cvt_pk_bf16_f32 v81, v66, v67
    v_cvt_pk_bf16_f32 v82, v68, v69
    v_cvt_pk_bf16_f32 v83, v70, v71
    ds_write_b128 v146, v[80:83] offset:0
    v_cvt_pk_bf16_f32 v84, v65, v66
    v_cvt_pk_bf16_f32 v85, v67, v68
    v_cvt_pk_bf16_f32 v86, v69, v70
    v_cvt_pk_bf16_f32 v87, v71, v72
    ds_write_b128 v146, v[84:87] offset:4160
    v_cvt_pk_bf16_f32 v88, v66, v67
    v_cvt_pk_bf16_f32 v89, v68, v69
    v_cvt_pk_bf16_f32 v90, v70, v71
    v_cvt_pk_bf16_f32 v91, v72, v73
    ds_write_b128 v146, v[88:91] offset:8320
    v_cvt_pk_bf16_f32 v92, v67, v68
    v_cvt_pk_bf16_f32 v93, v69, v70
    v_cvt_pk_bf16_f32 v94, v71, v72
    v_cvt_pk_bf16_f32 v95, v73, v74
    ds_write_b128 v146, v[92:95] offset:12480
    v_cndmask_b32 v77, v75, v76, s[58:59]
    v_cvt_pk_bf16_f32 v80, v75, v75
    v_cvt_pk_bf16_f32 v81, v75, v75
    v_cvt_pk_bf16_f32 v82, v77, v76
    v_cvt_pk_bf16_f32 v83, v76, v76
    ds_write_b128 v146, v[80:83] offset:2048
    v_cvt_pk_bf16_f32 v84, v75, v75
    v_cvt_pk_bf16_f32 v85, v75, v77
    v_cvt_pk_bf16_f32 v86, v76, v76
    v_cvt_pk_bf16_f32 v87, v76, v76
    ds_write_b128 v146, v[84:87] offset:6208
    v_cvt_pk_bf16_f32 v88, v75, v75
    v_cvt_pk_bf16_f32 v89, v77, v76
    v_cvt_pk_bf16_f32 v90, v76, v76
    v_cvt_pk_bf16_f32 v91, v76, v76
    ds_write_b128 v146, v[88:91] offset:10368
    v_cvt_pk_bf16_f32 v92, v75, v77
    v_cvt_pk_bf16_f32 v93, v76, v76
    v_cvt_pk_bf16_f32 v94, v76, v76
    v_cvt_pk_bf16_f32 v95, v76, v76
    ds_write_b128 v146, v[92:95] offset:14528
    v_cvt_pk_bf16_f32 v96, 0, v64
    v_cvt_pk_bf16_f32 v97, v65, v66
    v_cvt_pk_bf16_f32 v98, v64, v65
    v_subrev_u32 v99, 16, v146
    s_mov_b64 exec, 1
    ds_write_b32 v99, v96 offset:4172
    ds_write_b32 v99, v98 offset:8332
    ds_write_b64 v99, v[96:97] offset:12488
    s_mov_b64 exec, -1
    s_branch L_kwin_done
L_kwin_b:
    v_cvt_pk_bf16_f32 v80, v64, v64
    v_cvt_pk_bf16_f32 v81, v64, v65
    v_cvt_pk_bf16_f32 v82, v65, v65
    v_cvt_pk_bf16_f32 v83, v66, v66
    ds_write_b128 v146, v[80:83] offset:0
    v_cvt_pk_bf16_f32 v84, v64, v64
    v_cvt_pk_bf16_f32 v85, v65, v65
    v_cvt_pk_bf16_f32 v86, v65, v66
    v_cvt_pk_bf16_f32 v87, v66, v66
    ds_write_b128 v146, v[84:87] offset:4160
    v_cvt_pk_bf16_f32 v88, v64, v65
    v_cvt_pk_bf16_f32 v89, v65, v65
    v_cvt_pk_bf16_f32 v90, v66, v66
    v_cvt_pk_bf16_f32 v91, v66, v66
    ds_write_b128 v146, v[88:91] offset:8320
    v_cvt_pk_bf16_f32 v92, v65, v65
    v_cvt_pk_bf16_f32 v93, v65, v66
    v_cvt_pk_bf16_f32 v94, v66, v66
    v_cvt_pk_bf16_f32 v95, v66, v66
    ds_write_b128 v146, v[92:95] offset:12480
    v_cndmask_b32 v77, v67, v68, s[58:59]
    v_cvt_pk_bf16_f32 v80, v67, v67
    v_cvt_pk_bf16_f32 v81, v67, v67
    v_cvt_pk_bf16_f32 v82, v77, v68
    v_cvt_pk_bf16_f32 v83, v68, v68
    ds_write_b128 v146, v[80:83] offset:2048
    v_cvt_pk_bf16_f32 v84, v67, v67
    v_cvt_pk_bf16_f32 v85, v67, v77
    v_cvt_pk_bf16_f32 v86, v68, v68
    v_cvt_pk_bf16_f32 v87, v68, v68
    ds_write_b128 v146, v[84:87] offset:6208
    v_cvt_pk_bf16_f32 v88, v67, v67
    v_cvt_pk_bf16_f32 v89, v77, v68
    v_cvt_pk_bf16_f32 v90, v68, v68
    v_cvt_pk_bf16_f32 v91, v68, v68
    ds_write_b128 v146, v[88:91] offset:10368
    v_cvt_pk_bf16_f32 v92, v67, v77
    v_cvt_pk_bf16_f32 v93, v68, v68
    v_cvt_pk_bf16_f32 v94, v68, v68
    v_cvt_pk_bf16_f32 v95, v68, v68
    ds_write_b128 v146, v[92:95] offset:14528
L_kwin_done:
    s_lshl_b32 s51, 16, s4
    s_mov_b64 exec, 1
    v_mov_b32 v20, s51
    ds_or_b32 v160, v20
    s_mov_b64 exec, -1
    s_setprio 2
    s_lshl_b32 s51, 80, s43
L_ws_2:
    ds_read_b32 v20, v160
    s_sub_u32 s88, s88, 1
    s_cbranch_scc1 L_exit
    s_waitcnt lgkmcnt(0)
    v_readfirstlane_b32 s7, v20
    s_and_b32 s7, s7, s51
    s_cmp_eq_u32 s7, s51
    s_cbranch_scc0 L_ws_2
    s_cmp_eq_u32 s50, 0
    s_cbranch_scc0 L_conv_y
    ds_read_b64 v[64:65], v143 offset:3584
    ds_read_b64 v[66:67], v143 offset:3592
    ds_read_b64 v[68:69], v143 offset:3072
    ds_read_b64 v[70:71], v143 offset:3080
    ds_read_b64 v[72:73], v143 offset:2560
    ds_read_b64 v[74:75], v143 offset:2568
    ds_read_b64 v[76:77], v143 offset:2048
    ds_read_b64 v[78:79], v143 offset:2056
L_ws_3:
    ds_read_b32 v20, v160
    s_sub_u32 s88, s88, 1
    s_cbranch_scc1 L_exit
    s_waitcnt lgkmcnt(0)
    v_readfirstlane_b32 s7, v20
    s_and_b32 s7, s7, 15
    s_cmp_eq_u32 s7, 15
    s_cbranch_scc0 L_ws_3
    ds_read_b128 v[80:83], v144 offset:448
    ds_read_b128 v[84:87], v144 offset:960
    ds_read_b128 v[88:91], v144 offset:1472
    ds_read_b128 v[92:95], v144 offset:1984
    ds_read_b64 v[96:97], v143 offset:1536
    ds_read_b64 v[98:99], v143 offset:1544
    ds_read_b128 v[100:103], v144 offset:2496
    ds_read_b64 v[104:105], v143 offset:1024
    ds_read_b64 v[106:107], v143 offset:1032
    ds_read_b128 v[108:111], v144 offset:3008
    s_waitcnt lgkmcnt(9)
    v_mfma_f32_16x16x32_bf16 v[40:43], v[64:67], v[80:83], 0
    s_waitcnt lgkmcnt(8)
    v_mfma_f32_16x16x32_bf16 v[40:43], v[68:71], v[84:87], v[40:43]
    v_mfma_f32_16x16x32_bf16 v[44:47], v[68:71], v[80:83], 0
    s_waitcnt lgkmcnt(7)
    v_mfma_f32_16x16x32_bf16 v[40:43], v[72:75], v[88:91], v[40:43]
    ds_read_b64 v[112:113], v143 offset:512
    ds_read_b64 v[114:115], v143 offset:520
    ds_read_b128 v[116:119], v144 offset:3520
    v_mfma_f32_16x16x32_bf16 v[44:47], v[72:75], v[84:87], v[44:47]
    s_waitcnt lgkmcnt(9)
    v_mfma_f32_16x16x32_bf16 v[40:43], v[76:79], v[92:95], v[40:43]
    ds_read_b64 v[120:121], v143 offset:0
    ds_read_b64 v[122:123], v143 offset:8
    v_mfma_f32_16x16x32_bf16 v[44:47], v[76:79], v[88:91], v[44:47]
    ds_read_b128 v[124:127], v144 offset:4032
    s_waitcnt lgkmcnt(9)
    v_mfma_f32_16x16x32_bf16 v[40:43], v[96:99], v[100:103], v[40:43]
    ds_read_b64 v[64:65], v143 offset:3648
    ds_read_b64 v[66:67], v143 offset:3656
    v_mfma_f32_16x16x32_bf16 v[44:47], v[96:99], v[92:95], v[44:47]
    ds_read_b128 v[68:71], v144 offset:384
    s_waitcnt lgkmcnt(9)
    v_mfma_f32_16x16x32_bf16 v[40:43], v[104:107], v[108:111], v[40:43]
    ds_read_b64 v[72:73], v143 offset:3136
    ds_read_b64 v[74:75], v143 offset:3144
    v_mfma_f32_16x16x32_bf16 v[44:47], v[104:107], v[100:103], v[44:47]
    ds_read_b128 v[76:79], v144 offset:896
    s_waitcnt lgkmcnt(9)
    v_mfma_f32_16x16x32_bf16 v[40:43], v[112:115], v[116:119], v[40:43]
    v_mfma_f32_16x16x32_bf16 v[44:47], v[112:115], v[108:111], v[44:47]
    ds_read_b64 v[88:89], v143 offset:2624
    ds_read_b64 v[90:91], v143 offset:2632
    ds_read_b128 v[96:99], v144 offset:1408
    v_mfma_f32_16x16x32_bf16 v[48:51], v[112:115], v[80:83], 0
    s_waitcnt lgkmcnt(9)
    v_mfma_f32_16x16x32_bf16 v[40:43], v[120:123], v[124:127], v[40:43]
    ds_read_b64 v[92:93], v143 offset:2112
    ds_read_b64 v[94:95], v143 offset:2120
    v_mfma_f32_16x16x32_bf16 v[44:47], v[120:123], v[116:119], v[44:47]
    ds_read_b128 v[104:107], v144 offset:1920
    v_mfma_f32_16x16x32_bf16 v[48:51], v[120:123], v[84:87], v[48:51]
    ds_read_b64 v[100:101], v143 offset:1600
    ds_read_b64 v[102:103], v143 offset:1608
    v_mfma_f32_16x16x32_bf16 v[52:55], v[120:123], v[80:83], 0
    ds_read_b128 v[108:111], v144 offset:2432
    s_waitcnt lgkmcnt(12)
    v_mfma_f32_16x16x32_bf16 v[40:43], v[64:67], v[68:71], v[40:43]
    ds_read_b64 v[112:113], v143 offset:1088
    ds_read_b64 v[114:115], v143 offset:1096
    s_waitcnt lgkmcnt(11)
    v_mfma_f32_16x16x32_bf16 v[40:43], v[72:75], v[76:79], v[40:43]
    ds_read_b128 v[124:127], v144 offset:2944
    v_mfma_f32_16x16x32_bf16 v[44:47], v[72:75], v[68:71], v[44:47]
    s_waitcnt lgkmcnt(9)
    v_mfma_f32_16x16x32_bf16 v[40:43], v[88:91], v[96:99], v[40:43]
    ds_read_b64 v[116:117], v143 offset:576
    ds_read_b64 v[118:119], v143 offset:584
    ds_read_b128 v[84:87], v144 offset:3456
    v_mfma_f32_16x16x32_bf16 v[44:47], v[88:91], v[76:79], v[44:47]
    s_waitcnt lgkmcnt(9)
    v_mfma_f32_16x16x32_bf16 v[40:43], v[92:95], v[104:107], v[40:43]
    ds_read_b64 v[120:121], v143 offset:64
    ds_read_b64 v[122:123], v143 offset:72
    v_mfma_f32_16x16x32_bf16 v[44:47], v[92:95], v[96:99], v[44:47]
    ds_read_b128 v[80:83], v144 offset:3968
    s_waitcnt lgkmcnt(9)
    v_mfma_f32_16x16x32_bf16 v[40:43], v[100:103], v[108:111], v[40:43]
    ds_read_b64 v[64:65], v143 offset:3712
    ds_read_b64 v[66:67], v143 offset:3720
    v_mfma_f32_16x16x32_bf16 v[44:47], v[100:103], v[104:107], v[44:47]
    ds_read_b128 v[72:75], v144 offset:320
    s_waitcnt lgkmcnt(9)
    v_mfma_f32_16x16x32_bf16 v[40:43], v[112:115], v[124:127], v[40:43]
    ds_read_b64 v[88:89], v143 offset:3200
    ds_read_b64 v[90:91], v143 offset:3208
    v_mfma_f32_16x16x32_bf16 v[44:47], v[112:115], v[108:111], v[44:47]
    ds_read_b128 v[92:95], v144 offset:832
    s_waitcnt lgkmcnt(9)
    v_mfma_f32_16x16x32_bf16 v[40:43], v[116:119], v[84:87], v[40:43]
    v_mfma_f32_16x16x32_bf16 v[44:47], v[116:119], v[124:127], v[44:47]
    ds_read_b64 v[96:97], v143 offset:2688
    ds_read_b64 v[98:99], v143 offset:2696
    ds_read_b128 v[100:103], v144 offset:1344
    v_mfma_f32_16x16x32_bf16 v[48:51], v[116:119], v[68:71], v[48:51]
    s_waitcnt lgkmcnt(9)
    v_mfma_f32_16x16x32_bf16 v[40:43], v[120:123], v[80:83], v[40:43]
    ds_read_b64 v[104:105], v143 offset:2176
    ds_read_b64 v[106:107], v143 offset:2184
    v_mfma_f32_16x16x32_bf16 v[44:47], v[120:123], v[84:87], v[44:47]
    ds_read_b128 v[112:115], v144 offset:1856
    v_mfma_f32_16x16x32_bf16 v[48:51], v[120:123], v[76:79], v[48:51]
    ds_read_b64 v[108:109], v143 offset:1664
    ds_read_b64 v[110:111], v143 offset:1672
    v_mfma_f32_16x16x32_bf16 v[52:55], v[120:123], v[68:71], v[52:55]
    ds_read_b128 v[124:127], v144 offset:2368
    s_waitcnt lgkmcnt(12)
    v_mfma_f32_16x16x32_bf16 v[40:43], v[64:67], v[72:75], v[40:43]
    ds_read_b64 v[116:117], v143 offset:1152
    ds_read_b64 v[118:119], v143 offset:1160
    s_waitcnt lgkmcnt(11)
    v_mfma_f32_16x16x32_bf16 v[40:43], v[88:91], v[92:95], v[40:43]
    ds_read_b128 v[80:83], v144 offset:2880
    v_mfma_f32_16x16x32_bf16 v[44:47], v[88:91], v[72:75], v[44:47]
    s_waitcnt lgkmcnt(9)
    v_mfma_f32_16x16x32_bf16 v[40:43], v[96:99], v[100:103], v[40:43]
    ds_read_b64 v[84:85], v143 offset:640
    ds_read_b64 v[86:87], v143 offset:648
    ds_read_b128 v[76:79], v144 offset:3392
    v_mfma_f32_16x16x32_bf16 v[44:47], v[96:99], v[92:95], v[44:47]
    s_waitcnt lgkmcnt(9)
    v_mfma_f32_16x16x32_bf16 v[40:43], v[104:107], v[112:115], v[40:43]
    ds_read_b64 v[120:121], v143 offset:128
    ds_read_b64 v[122:123], v143 offset:136
    v_mfma_f32_16x16x32_bf16 v[44:47], v[104:107], v[100:103], v[44:47]
    ds_read_b128 v[68:71], v144 offset:3904
    s_waitcnt lgkmcnt(9)
    v_mfma_f32_16x16x32_bf16 v[40:43], v[108:111], v[124:127], v[40:43]
    ds_read_b64 v[64:65], v143 offset:3776
    ds_read_b64 v[66:67], v143 offset:3784
    v_mfma_f32_16x16x32_bf16 v[44:47], v[108:111], v[112:115], v[44:47]
    ds_read_b128 v[88:91], v144 offset:256
    s_waitcnt lgkmcnt(9)
    v_mfma_f32_16x16x32_bf16 v[40:43], v[116:119], v[80:83], v[40:43]
    ds_read_b64 v[96:97], v143 offset:3264
    ds_read_b64 v[98:99], v143 offset:3272
    v_mfma_f32_16x16x32_bf16 v[44:47], v[116:119], v[124:127], v[44:47]
    ds_read_b128 v[104:107], v144 offset:768
    s_waitcnt lgkmcnt(9)
    v_mfma_f32_16x16x32_bf16 v[40:43], v[84:87], v[76:79], v[40:43]
    v_mfma_f32_16x16x32_bf16 v[44:47], v[84:87], v[80:83], v[44:47]
    ds_read_b64 v[100:101], v143 offset:2752
    ds_read_b64 v[102:103], v143 offset:2760
    ds_read_b128 v[108:111], v144 offset:1280
    v_mfma_f32_16x16x32_bf16 v[48:51], v[84:87], v[72:75], v[48:51]
    s_waitcnt lgkmcnt(9)
    v_mfma_f32_16x16x32_bf16 v[40:43], v[120:123], v[68:71], v[40:43]
    ds_read_b64 v[112:113], v143 offset:2240
    ds_read_b64 v[114:115], v143 offset:2248
    v_mfma_f32_16x16x32_bf16 v[44:47], v[120:123], v[76:79], v[44:47]
    ds_read_b128 v[116:119], v144 offset:1792
    v_mfma_f32_16x16x32_bf16 v[48:51], v[120:123], v[92:95], v[48:51]
    ds_read_b64 v[124:125], v143 offset:1728
    ds_read_b64 v[126:127], v143 offset:1736
    v_mfma_f32_16x16x32_bf16 v[52:55], v[120:123], v[72:75], v[52:55]
    ds_read_b128 v[80:83], v144 offset:2304
    s_waitcnt lgkmcnt(12)
    v_mfma_f32_16x16x32_bf16 v[40:43], v[64:67], v[88:91], v[40:43]
    ds_read_b64 v[84:85], v143 offset:1216
    ds_read_b64 v[86:87], v143 offset:1224
    s_waitcnt lgkmcnt(11)
    v_mfma_f32_16x16x32_bf16 v[40:43], v[96:99], v[104:107], v[40:43]
    ds_read_b128 v[68:71], v144 offset:2816
    v_mfma_f32_16x16x32_bf16 v[44:47], v[96:99], v[88:91], v[44:47]
    s_waitcnt lgkmcnt(9)
    v_mfma_f32_16x16x32_bf16 v[40:43], v[100:103], v[108:111], v[40:43]
    ds_read_b64 v[76:77], v143 offset:704
    ds_read_b64 v[78:79], v143 offset:712
    ds_read_b128 v[92:95], v144 offset:3328
    v_mfma_f32_16x16x32_bf16 v[44:47], v[100:103], v[104:107], v[44:47]
    s_waitcnt lgkmcnt(9)
    v_mfma_f32_16x16x32_bf16 v[40:43], v[112:115], v[116:119], v[40:43]
    ds_read_b64 v[120:121], v143 offset:192
    ds_read_b64 v[122:123], v143 offset:200
    v_mfma_f32_16x16x32_bf16 v[44:47], v[112:115], v[108:111], v[44:47]
    ds_read_b128 v[72:75], v144 offset:3840
    s_waitcnt lgkmcnt(9)
    v_mfma_f32_16x16x32_bf16 v[40:43], v[124:127], v[80:83], v[40:43]
    ds_read_b64 v[64:65], v143 offset:3840
    ds_read_b64 v[66:67], v143 offset:3848
    v_mfma_f32_16x16x32_bf16 v[44:47], v[124:127], v[116:119], v[44:47]
    ds_read_b128 v[96:99], v144 offset:192
    s_waitcnt lgkmcnt(9)
    v_mfma_f32_16x16x32_bf16 v[40:43], v[84:87], v[68:71], v[40:43]
    ds_read_b64 v[100:101], v143 offset:3328
    ds_read_b64 v[102:103], v143 offset:3336
    v_mfma_f32_16x16x32_bf16 v[44:47], v[84:87], v[80:83], v[44:47]
    ds_read_b128 v[112:115], v144 offset:704
    s_waitcnt lgkmcnt(9)
    v_mfma_f32_16x16x32_bf16 v[40:43], v[76:79], v[92:95], v[40:43]
    v_mfma_f32_16x16x32_bf16 v[44:47], v[76:79], v[68:71], v[44:47]
    ds_read_b64 v[108:109], v143 offset:2816
    ds_read_b64 v[110:111], v143 offset:2824
    ds_read_b128 v[124:127], v144 offset:1216
    v_mfma_f32_16x16x32_bf16 v[48:51], v[76:79], v[88:91], v[48:51]
    s_waitcnt lgkmcnt(9)
    v_mfma_f32_16x16x32_bf16 v[40:43], v[120:123], v[72:75], v[40:43]
    ds_read_b64 v[116:117], v143 offset:2304
    ds_read_b64 v[118:119], v143 offset:2312
    v_mfma_f32_16x16x32_bf16 v[44:47], v[120:123], v[92:95], v[44:47]
    ds_read_b128 v[84:87], v144 offset:1728
    v_mfma_f32_16x16x32_bf16 v[48:51], v[120:123], v[104:107], v[48:51]
    ds_read_b64 v[80:81], v143 offset:1792
    ds_read_b64 v[82:83], v143 offset:1800
    v_mfma_f32_16x16x32_bf16 v[52:55], v[120:123], v[88:91], v[52:55]
    ds_read_b128 v[68:71], v144 offset:2240
    s_waitcnt lgkmcnt(12)
    v_mfma_f32_16x16x32_bf16 v[40:43], v[64:67], v[96:99], v[40:43]
    ds_read_b64 v[76:77], v143 offset:1280
    ds_read_b64 v[78:79], v143 offset:1288
    s_waitcnt lgkmcnt(11)
    v_mfma_f32_16x16x32_bf16 v[40:43], v[100:103], v[112:115], v[40:43]
    ds_read_b128 v[72:75], v144 offset:2752
    v_mfma_f32_16x16x32_bf16 v[44:47], v[100:103], v[96:99], v[44:47]
    s_waitcnt lgkmcnt(9)
    v_mfma_f32_16x16x32_bf16 v[40:43], v[108:111], v[124:127], v[40:43]
    ds_read_b64 v[92:93], v143 offset:768
    ds_read_b64 v[94:95], v143 offset:776
    ds_read_b128 v[104:107], v144 offset:3264
    v_mfma_f32_16x16x32_bf16 v[44:47], v[108:111], v[112:115], v[44:47]
    s_waitcnt lgkmcnt(9)
    v_mfma_f32_16x16x32_bf16 v[40:43], v[116:119], v[84:87], v[40:43]
    ds_read_b64 v[120:121], v143 offset:256
    ds_read_b64 v[122:123], v143 offset:264
    v_mfma_f32_16x16x32_bf16 v[44:47], v[116:119], v[124:127], v[44:47]
    ds_read_b128 v[88:91], v144 offset:3776
    s_waitcnt lgkmcnt(9)
    v_mfma_f32_16x16x32_bf16 v[40:43], v[80:83], v[68:71], v[40:43]
    ds_read_b64 v[64:65], v143 offset:3904
    ds_read_b64 v[66:67], v143 offset:3912
    v_mfma_f32_16x16x32_bf16 v[44:47], v[80:83], v[84:87], v[44:47]
    ds_read_b128 v[100:103], v144 offset:128
    s_waitcnt lgkmcnt(9)
    v_mfma_f32_16x16x32_bf16 v[40:43], v[76:79], v[72:75], v[40:43]
    ds_read_b64 v[108:109], v143 offset:3392
    ds_read_b64 v[110:111], v143 offset:3400
    v_mfma_f32_16x16x32_bf16 v[44:47], v[76:79], v[68:71], v[44:47]
    ds_read_b128 v[116:119], v144 offset:640
    s_waitcnt lgkmcnt(9)
    v_mfma_f32_16x16x32_bf16 v[40:43], v[92:95], v[104:107], v[40:43]
    v_mfma_f32_16x16x32_bf16 v[44:47], v[92:95], v[72:75], v[44:47]
    ds_read_b64 v[124:125], v143 offset:2880
    ds_read_b64 v[126:127], v143 offset:2888
    ds_read_b128 v[80:83], v144 offset:1152
    v_mfma_f32_16x16x32_bf16 v[48:51], v[92:95], v[96:99], v[48:51]
    s_waitcnt lgkmcnt(9)
    v_mfma_f32_16x16x32_bf16 v[40:43], v[120:123], v[88:91], v[40:43]
    ds_read_b64 v[84:85], v143 offset:2368
    ds_read_b64 v[86:87], v143 offset:2376
    v_mfma_f32_16x16x32_bf16 v[44:47], v[120:123], v[104:107], v[44:47]
    ds_read_b128 v[76:79], v144 offset:1664
    v_mfma_f32_16x16x32_bf16 v[48:51], v[120:123], v[112:115], v[48:51]
    ds_read_b64 v[68:69], v143 offset:1856
    ds_read_b64 v[70:71], v143 offset:1864
    v_mfma_f32_16x16x32_bf16 v[52:55], v[120:123], v[96:99], v[52:55]
    ds_read_b128 v[72:75], v144 offset:2176
    s_waitcnt lgkmcnt(12)
    v_mfma_f32_16x16x32_bf16 v[40:43], v[64:67], v[100:103], v[40:43]
    ds_read_b64 v[92:93], v143 offset:1344
    ds_read_b64 v[94:95], v143 offset:1352
    s_waitcnt lgkmcnt(11)
    v_mfma_f32_16x16x32_bf16 v[40:43], v[108:111], v[116:119], v[40:43]
    ds_read_b128 v[88:91], v144 offset:2688
    v_mfma_f32_16x16x32_bf16 v[44:47], v[108:111], v[100:103], v[44:47]
    s_waitcnt lgkmcnt(9)
    v_mfma_f32_16x16x32_bf16 v[40:43], v[124:127], v[80:83], v[40:43]
    ds_read_b64 v[104:105], v143 offset:832
    ds_read_b64 v[106:107], v143 offset:840
    ds_read_b128 v[112:115], v144 offset:3200
    v_mfma_f32_16x16x32_bf16 v[44:47], v[124:127], v[116:119], v[44:47]
    s_waitcnt lgkmcnt(9)
    v_mfma_f32_16x16x32_bf16 v[40:43], v[84:87], v[76:79], v[40:43]
    ds_read_b64 v[120:121], v143 offset:320
    ds_read_b64 v[122:123], v143 offset:328
    v_mfma_f32_16x16x32_bf16 v[44:47], v[84:87], v[80:83], v[44:47]
    ds_read_b128 v[96:99], v144 offset:3712
    s_waitcnt lgkmcnt(9)
    v_mfma_f32_16x16x32_bf16 v[40:43], v[68:71], v[72:75], v[40:43]
    ds_read_b64 v[64:65], v143 offset:3968
    ds_read_b64 v[66:67], v143 offset:3976
    v_mfma_f32_16x16x32_bf16 v[44:47], v[68:71], v[76:79], v[44:47]
    ds_read_b128 v[108:111], v144 offset:64
    s_waitcnt lgkmcnt(9)
    v_mfma_f32_16x16x32_bf16 v[40:43], v[92:95], v[88:91], v[40:43]
    ds_read_b64 v[124:125], v143 offset:3456
    ds_read_b64 v[126:127], v143 offset:3464
    v_mfma_f32_16x16x32_bf16 v[44:47], v[92:95], v[72:75], v[44:47]
    ds_read_b128 v[84:87], v144 offset:576
    s_waitcnt lgkmcnt(9)
    v_mfma_f32_16x16x32_bf16 v[40:43], v[104:107], v[112:115], v[40:43]
    v_mfma_f32_16x16x32_bf16 v[44:47], v[104:107], v[88:91], v[44:47]
    ds_read_b64 v[80:81], v143 offset:2944
    ds_read_b64 v[82:83], v143 offset:2952
    ds_read_b128 v[68:71], v144 offset:1088
    v_mfma_f32_16x16x32_bf16 v[48:51], v[104:107], v[100:103], v[48:51]
    s_waitcnt lgkmcnt(9)
    v_mfma_f32_16x16x32_bf16 v[40:43], v[120:123], v[96:99], v[40:43]
    ds_read_b64 v[76:77], v143 offset:2432
    ds_read_b64 v[78:79], v143 offset:2440
    v_mfma_f32_16x16x32_bf16 v[44:47], v[120:123], v[112:115], v[44:47]
    ds_read_b128 v[92:95], v144 offset:1600
    v_mfma_f32_16x16x32_bf16 v[48:51], v[120:123], v[116:119], v[48:51]
    ds_read_b64 v[72:73], v143 offset:1920
    ds_read_b64 v[74:75], v143 offset:1928
    v_mfma_f32_16x16x32_bf16 v[52:55], v[120:123], v[100:103], v[52:55]
    ds_read_b128 v[88:91], v144 offset:2112
    s_waitcnt lgkmcnt(12)
    v_mfma_f32_16x16x32_bf16 v[40:43], v[64:67], v[108:111], v[40:43]
    ds_read_b64 v[104:105], v143 offset:1408
    ds_read_b64 v[106:107], v143 offset:1416
    s_waitcnt lgkmcnt(11)
    v_mfma_f32_16x16x32_bf16 v[40:43], v[124:127], v[84:87], v[40:43]
    ds_read_b128 v[96:99], v144 offset:2624
    v_mfma_f32_16x16x32_bf16 v[44:47], v[124:127], v[108:111], v[44:47]
    s_waitcnt lgkmcnt(9)
    v_mfma_f32_16x16x32_bf16 v[40:43], v[80:83], v[68:71], v[40:43]
    ds_read_b64 v[112:113], v143 offset:896
    ds_read_b64 v[114:115], v143 offset:904
    ds_read_b128 v[116:119], v144 offset:3136
    v_mfma_f32_16x16x32_bf16 v[44:47], v[80:83], v[84:87], v[44:47]
    s_waitcnt lgkmcnt(9)
    v_mfma_f32_16x16x32_bf16 v[40:43], v[76:79], v[92:95], v[40:43]
    ds_read_b64 v[120:121], v143 offset:384
    ds_read_b64 v[122:123], v143 offset:392
    v_mfma_f32_16x16x32_bf16 v[44:47], v[76:79], v[68:71], v[44:47]
    ds_read_b128 v[100:103], v144 offset:3648
    s_waitcnt lgkmcnt(9)
    v_mfma_f32_16x16x32_bf16 v[40:43], v[72:75], v[88:91], v[40:43]
    ds_read_b64 v[64:65], v143 offset:4032
    ds_read_b64 v[66:67], v143 offset:4040
    v_mfma_f32_16x16x32_bf16 v[44:47], v[72:75], v[92:95], v[44:47]
    ds_read_b128 v[124:127], v144 offset:0
    s_waitcnt lgkmcnt(9)
    v_mfma_f32_16x16x32_bf16 v[40:43], v[104:107], v[96:99], v[40:43]
    ds_read_b64 v[80:81], v143 offset:3520
    ds_read_b64 v[82:83], v143 offset:3528
    v_mfma_f32_16x16x32_bf16 v[44:47], v[104:107], v[88:91], v[44:47]
    ds_read_b128 v[76:79], v144 offset:512
    s_waitcnt lgkmcnt(9)
    v_mfma_f32_16x16x32_bf16 v[40:43], v[112:115], v[116:119], v[40:43]
    v_mfma_f32_16x16x32_bf16 v[44:47], v[112:115], v[96:99], v[44:47]
    ds_read_b64 v[68:69], v143 offset:3008
    ds_read_b64 v[70:71], v143 offset:3016
    ds_read_b128 v[72:75], v144 offset:1024
    v_mfma_f32_16x16x32_bf16 v[48:51], v[112:115], v[108:111], v[48:51]
    s_waitcnt lgkmcnt(9)
    v_mfma_f32_16x16x32_bf16 v[40:43], v[120:123], v[100:103], v[40:43]
    ds_read_b64 v[92:93], v143 offset:2496
    ds_read_b64 v[94:95], v143 offset:2504
    v_mfma_f32_16x16x32_bf16 v[44:47], v[120:123], v[116:119], v[44:47]
    ds_read_b128 v[104:107], v144 offset:1536
    v_mfma_f32_16x16x32_bf16 v[48:51], v[120:123], v[84:87], v[48:51]
    ds_read_b64 v[88:89], v143 offset:1984
    ds_read_b64 v[90:91], v143 offset:1992
    v_mfma_f32_16x16x32_bf16 v[52:55], v[120:123], v[108:111], v[52:55]
    ds_read_b128 v[96:99], v144 offset:2048
    s_waitcnt lgkmcnt(12)
    v_mfma_f32_16x16x32_bf16 v[40:43], v[64:67], v[124:127], v[40:43]
    ds_read_b64 v[112:113], v143 offset:1472
    ds_read_b64 v[114:115], v143 offset:1480
    s_waitcnt lgkmcnt(11)
    v_mfma_f32_16x16x32_bf16 v[40:43], v[80:83], v[76:79], v[40:43]
    ds_read_b128 v[100:103], v144 offset:2560
    v_mfma_f32_16x16x32_bf16 v[44:47], v[80:83], v[124:127], v[44:47]
    s_waitcnt lgkmcnt(9)
    v_mfma_f32_16x16x32_bf16 v[40:43], v[68:71], v[72:75], v[40:43]
    ds_read_b64 v[116:117], v143 offset:960
    ds_read_b64 v[118:119], v143 offset:968
    ds_read_b128 v[84:87], v144 offset:3072
    v_mfma_f32_16x16x32_bf16 v[44:47], v[68:71], v[76:79], v[44:47]
    s_waitcnt lgkmcnt(9)
    v_mfma_f32_16x16x32_bf16 v[40:43], v[92:95], v[104:107], v[40:43]
    ds_read_b64 v[120:121], v143 offset:448
    ds_read_b64 v[122:123], v143 offset:456
    v_mfma_f32_16x16x32_bf16 v[44:47], v[92:95], v[72:75], v[44:47]
    ds_read_b128 v[108:111], v144 offset:3584
    s_waitcnt lgkmcnt(9)
    v_mfma_f32_16x16x32_bf16 v[40:43], v[88:91], v[96:99], v[40:43]
    v_mfma_f32_16x16x32_bf16 v[44:47], v[88:91], v[104:107], v[44:47]
    s_waitcnt lgkmcnt(6)
    v_mfma_f32_16x16x32_bf16 v[40:43], v[112:115], v[100:103], v[40:43]
    v_mfma_f32_16x16x32_bf16 v[44:47], v[112:115], v[96:99], v[44:47]
    s_waitcnt lgkmcnt(3)
    v_mfma_f32_16x16x32_bf16 v[40:43], v[116:119], v[84:87], v[40:43]
    v_mfma_f32_16x16x32_bf16 v[44:47], v[116:119], v[100:103], v[44:47]
    v_mfma_f32_16x16x32_bf16 v[48:51], v[116:119], v[124:127], v[48:51]
    s_waitcnt lgkmcnt(0)
    v_mfma_f32_16x16x32_bf16 v[40:43], v[120:123], v[108:111], v[40:43]
    v_mfma_f32_16x16x32_bf16 v[44:47], v[120:123], v[84:87], v[44:47]
    v_mfma_f32_16x16x32_bf16 v[48:51], v[120:123], v[76:79], v[48:51]
    v_mfma_f32_16x16x32_bf16 v[52:55], v[120:123], v[124:127], v[52:55]
    s_nop 7
    v_cvt_pk_bf16_f32 v20, v52, v53
    v_cvt_pk_bf16_f32 v21, v54, v55
    ds_write_b64 v145, v[20:21] offset:0
    v_cvt_pk_bf16_f32 v22, v48, v49
    v_cvt_pk_bf16_f32 v23, v50, v51
    ds_write_b64 v145, v[22:23] offset:512
    v_cvt_pk_bf16_f32 v24, v44, v45
    v_cvt_pk_bf16_f32 v25, v46, v47
    ds_write_b64 v145, v[24:25] offset:3072
    v_cvt_pk_bf16_f32 v26, v40, v41
    v_cvt_pk_bf16_f32 v27, v42, v43
    ds_write_b64 v145, v[26:27] offset:3584
    s_lshl_b32 s51, 16640, s43
    s_mov_b64 exec, 1
    v_mov_b32 v28, s51
    ds_or_b32 v160, v28
    s_mov_b64 exec, -1
    s_endpgm
L_conv_y:
    ds_read_b64 v[64:65], v143 offset:2560
    ds_read_b64 v[66:67], v143 offset:2568
    ds_read_b64 v[68:69], v143 offset:2048
    ds_read_b64 v[70:71], v143 offset:2056
    ds_read_b64 v[72:73], v143 offset:1536
    ds_read_b64 v[74:75], v143 offset:1544
    ds_read_b64 v[76:77], v143 offset:1024
    ds_read_b64 v[78:79], v143 offset:1032
L_ws_4:
    ds_read_b32 v20, v160
    s_sub_u32 s88, s88, 1
    s_cbranch_scc1 L_exit
    s_waitcnt lgkmcnt(0)
    v_readfirstlane_b32 s7, v20
    s_and_b32 s7, s7, 15
    s_cmp_eq_u32 s7, 15
    s_cbranch_scc0 L_ws_4
    ds_read_b128 v[80:83], v144 offset:448
    ds_read_b128 v[84:87], v144 offset:960
    ds_read_b128 v[88:91], v144 offset:1472
    ds_read_b128 v[92:95], v144 offset:1984
    ds_read_b64 v[96:97], v143 offset:512
    ds_read_b64 v[98:99], v143 offset:520
    ds_read_b128 v[100:103], v144 offset:2496
    ds_read_b64 v[104:105], v143 offset:0
    ds_read_b64 v[106:107], v143 offset:8
    ds_read_b128 v[108:111], v144 offset:3008
    s_waitcnt lgkmcnt(9)
    v_mfma_f32_16x16x32_bf16 v[40:43], v[64:67], v[80:83], 0
    s_waitcnt lgkmcnt(8)
    v_mfma_f32_16x16x32_bf16 v[40:43], v[68:71], v[84:87], v[40:43]
    v_mfma_f32_16x16x32_bf16 v[44:47], v[68:71], v[80:83], 0
    s_waitcnt lgkmcnt(7)
    v_mfma_f32_16x16x32_bf16 v[40:43], v[72:75], v[88:91], v[40:43]
    v_mfma_f32_16x16x32_bf16 v[44:47], v[72:75], v[84:87], v[44:47]
    ds_read_b64 v[112:113], v143 offset:2624
    ds_read_b64 v[114:115], v143 offset:2632
    v_mfma_f32_16x16x32_bf16 v[48:51], v[72:75], v[80:83], 0
    ds_read_b128 v[116:119], v144 offset:384
    s_waitcnt lgkmcnt(9)
    v_mfma_f32_16x16x32_bf16 v[40:43], v[76:79], v[92:95], v[40:43]
    v_mfma_f32_16x16x32_bf16 v[44:47], v[76:79], v[88:91], v[44:47]
    ds_read_b64 v[120:121], v143 offset:2112
    ds_read_b64 v[122:123], v143 offset:2120
    v_mfma_f32_16x16x32_bf16 v[48:51], v[76:79], v[84:87], v[48:51]
    ds_read_b128 v[124:127], v144 offset:896
    v_mfma_f32_16x16x32_bf16 v[52:55], v[76:79], v[80:83], 0
    s_waitcnt lgkmcnt(9)
    v_mfma_f32_16x16x32_bf16 v[40:43], v[96:99], v[100:103], v[40:43]
    ds_read_b64 v[64:65], v143 offset:1600
    ds_read_b64 v[66:67], v143 offset:1608
    v_mfma_f32_16x16x32_bf16 v[44:47], v[96:99], v[92:95], v[44:47]
    ds_read_b128 v[68:71], v144 offset:1408
    v_mfma_f32_16x16x32_bf16 v[48:51], v[96:99], v[88:91], v[48:51]
    v_mfma_f32_16x16x32_bf16 v[52:55], v[96:99], v[84:87], v[52:55]
    ds_read_b64 v[72:73], v143 offset:1088
    ds_read_b64 v[74:75], v143 offset:1096
    s_waitcnt lgkmcnt(11)
    v_mfma_f32_16x16x32_bf16 v[40:43], v[104:107], v[108:111], v[40:43]
    ds_read_b128 v[76:79], v144 offset:1920
    v_mfma_f32_16x16x32_bf16 v[44:47], v[104:107], v[100:103], v[44:47]
    v_mfma_f32_16x16x32_bf16 v[48:51], v[104:107], v[92:95], v[48:51]
    ds_read_b64 v[80:81], v143 offset:576
    ds_read_b64 v[82:83], v143 offset:584
    v_mfma_f32_16x16x32_bf16 v[52:55], v[104:107], v[88:91], v[52:55]
    ds_read_b128 v[96:99], v144 offset:2432
    s_waitcnt lgkmcnt(12)
    v_mfma_f32_16x16x32_bf16 v[40:43], v[112:115], v[116:119], v[40:43]
    s_waitcnt lgkmcnt(9)
    v_mfma_f32_16x16x32_bf16 v[40:43], v[120:123], v[124:127], v[40:43]
    ds_read_b64 v[84:85], v143 offset:64
    ds_read_b64 v[86:87], v143 offset:72
    v_mfma_f32_16x16x32_bf16 v[44:47], v[120:123], v[116:119], v[44:47]
    ds_read_b128 v[108:111], v144 offset:2944
    s_waitcnt lgkmcnt(9)
    v_mfma_f32_16x16x32_bf16 v[40:43], v[64:67], v[68:71], v[40:43]
    v_mfma_f32_16x16x32_bf16 v[44:47], v[64:67], v[124:127], v[44:47]
    ds_read_b64 v[100:101], v143 offset:2688
    ds_read_b64 v[102:103], v143 offset:2696
    v_mfma_f32_16x16x32_bf16 v[48:51], v[64:67], v[116:119], v[48:51]
    ds_read_b128 v[92:95], v144 offset:320
    s_waitcnt lgkmcnt(9)
    v_mfma_f32_16x16x32_bf16 v[40:43], v[72:75], v[76:79], v[40:43]
    v_mfma_f32_16x16x32_bf16 v[44:47], v[72:75], v[68:71], v[44:47]
    ds_read_b64 v[104:105], v143 offset:2176
    ds_read_b64 v[106:107], v143 offset:2184
    v_mfma_f32_16x16x32_bf16 v[48:51], v[72:75], v[124:127], v[48:51]
    ds_read_b128 v[88:91], v144 offset:832
    v_mfma_f32_16x16x32_bf16 v[52:55], v[72:75], v[116:119], v[52:55]
    s_waitcnt lgkmcnt(9)
    v_mfma_f32_16x16x32_bf16 v[40:43], v[80:83], v[96:99], v[40:43]
    ds_read_b64 v[112:113], v143 offset:1664
    ds_read_b64 v[114:115], v143 offset:1672
    v_mfma_f32_16x16x32_bf16 v[44:47], v[80:83], v[76:79], v[44:47]
    ds_read_b128 v[120:123], v144 offset:1344
    v_mfma_f32_16x16x32_bf16 v[48:51], v[80:83], v[68:71], v[48:51]
    v_mfma_f32_16x16x32_bf16 v[52:55], v[80:83], v[124:127], v[52:55]
    ds_read_b64 v[64:65], v143 offset:1152
    ds_read_b64 v[66:67], v143 offset:1160
    s_waitcnt lgkmcnt(11)
    v_mfma_f32_16x16x32_bf16 v[40:43], v[84:87], v[108:111], v[40:43]
    ds_read_b128 v[72:75], v144 offset:1856
    v_mfma_f32_16x16x32_bf16 v[44:47], v[84:87], v[96:99], v[44:47]
    v_mfma_f32_16x16x32_bf16 v[48:51], v[84:87], v[76:79], v[48:51]
    ds_read_b64 v[116:117], v143 offset:640
    ds_read_b64 v[118:119], v143 offset:648
    v_mfma_f32_16x16x32_bf16 v[52:55], v[84:87], v[68:71], v[52:55]
    ds_read_b128 v[80:83], v144 offset:2368
    s_waitcnt lgkmcnt(12)
    v_mfma_f32_16x16x32_bf16 v[40:43], v[100:103], v[92:95], v[40:43]
    s_waitcnt lgkmcnt(9)
    v_mfma_f32_16x16x32_bf16 v[40:43], v[104:107], v[88:91], v[40:43]
    ds_read_b64 v[124:125], v143 offset:128
    ds_read_b64 v[126:127], v143 offset:136
    v_mfma_f32_16x16x32_bf16 v[44:47], v[104:107], v[92:95], v[44:47]
    ds_read_b128 v[108:111], v144 offset:2880
    s_waitcnt lgkmcnt(9)
    v_mfma_f32_16x16x32_bf16 v[40:43], v[112:115], v[120:123], v[40:43]
    v_mfma_f32_16x16x32_bf16 v[44:47], v[112:115], v[88:91], v[44:47]
    ds_read_b64 v[96:97], v143 offset:2752
    ds_read_b64 v[98:99], v143 offset:2760
    v_mfma_f32_16x16x32_bf16 v[48:51], v[112:115], v[92:95], v[48:51]
    ds_read_b128 v[76:79], v144 offset:256
    s_waitcnt lgkmcnt(9)
    v_mfma_f32_16x16x32_bf16 v[40:43], v[64:67], v[72:75], v[40:43]
    v_mfma_f32_16x16x32_bf16 v[44:47], v[64:67], v[120:123], v[44:47]
    ds_read_b64 v[84:85], v143 offset:2240
    ds_read_b64 v[86:87], v143 offset:2248
    v_mfma_f32_16x16x32_bf16 v[48:51], v[64:67], v[88:91], v[48:51]
    ds_read_b128 v[68:71], v144 offset:768
    v_mfma_f32_16x16x32_bf16 v[52:55], v[64:67], v[92:95], v[52:55]
    s_waitcnt lgkmcnt(9)
    v_mfma_f32_16x16x32_bf16 v[40:43], v[116:119], v[80:83], v[40:43]
    ds_read_b64 v[100:101], v143 offset:1728
    ds_read_b64 v[102:103], v143 offset:1736
    v_mfma_f32_16x16x32_bf16 v[44:47], v[116:119], v[72:75], v[44:47]
    ds_read_b128 v[104:107], v144 offset:1280
    v_mfma_f32_16x16x32_bf16 v[48:51], v[116:119], v[120:123], v[48:51]
    v_mfma_f32_16x16x32_bf16 v[52:55], v[116:119], v[88:91], v[52:55]
    ds_read_b64 v[112:113], v143 offset:1216
    ds_read_b64 v[114:115], v143 offset:1224
    s_waitcnt lgkmcnt(11)
    v_mfma_f32_16x16x32_bf16 v[40:43], v[124:127], v[108:111], v[40:43]
    ds_read_b128 v[64:67], v144 offset:1792
    v_mfma_f32_16x16x32_bf16 v[44:47], v[124:127], v[80:83], v[44:47]
    v_mfma_f32_16x16x32_bf16 v[48:51], v[124:127], v[72:75], v[48:51]
    ds_read_b64 v[92:93], v143 offset:704
    ds_read_b64 v[94:95], v143 offset:712
    v_mfma_f32_16x16x32_bf16 v[52:55], v[124:127], v[120:123], v[52:55]
    ds_read_b128 v[116:119], v144 offset:2304
    s_waitcnt lgkmcnt(12)
    v_mfma_f32_16x16x32_bf16 v[40:43], v[96:99], v[76:79], v[40:43]
    s_waitcnt lgkmcnt(9)
    v_mfma_f32_16x16x32_bf16 v[40:43], v[84:87], v[68:71], v[40:43]
    ds_read_b64 v[88:89], v143 offset:192
    ds_read_b64 v[90:91], v143 offset:200
    v_mfma_f32_16x16x32_bf16 v[44:47], v[84:87], v[76:79], v[44:47]
    ds_read_b128 v[108:111], v144 offset:2816
    s_waitcnt lgkmcnt(9)
    v_mfma_f32_16x16x32_bf16 v[40:43], v[100:103], v[104:107], v[40:43]
    v_mfma_f32_16x16x32_bf16 v[44:47], v[100:103], v[68:71], v[44:47]
    ds_read_b64 v[80:81], v143 offset:2816
    ds_read_b64 v[82:83], v143 offset:2824
    v_mfma_f32_16x16x32_bf16 v[48:51], v[100:103], v[76:79], v[48:51]
    ds_read_b128 v[72:75], v144 offset:192
    s_waitcnt lgkmcnt(9)
    v_mfma_f32_16x16x32_bf16 v[40:43], v[112:115], v[64:67], v[40:43]
    v_mfma_f32_16x16x32_bf16 v[44:47], v[112:115], v[104:107], v[44:47]
    ds_read_b64 v[124:125], v143 offset:2304
    ds_read_b64 v[126:127], v143 offset:2312
    v_mfma_f32_16x16x32_bf16 v[48:51], v[112:115], v[68:71], v[48:51]
    ds_read_b128 v[120:123], v144 offset:704
    v_mfma_f32_16x16x32_bf16 v[52:55], v[112:115], v[76:79], v[52:55]
    s_waitcnt lgkmcnt(9)
    v_mfma_f32_16x16x32_bf16 v[40:43], v[92:95], v[116:119], v[40:43]
    ds_read_b64 v[96:97], v143 offset:1792
    ds_read_b64 v[98:99], v143 offset:1800
    v_mfma_f32_16x16x32_bf16 v[44:47], v[92:95], v[64:67], v[44:47]
    ds_read_b128 v[84:87], v144 offset:1216
    v_mfma_f32_16x16x32_bf16 v[48:51], v[92:95], v[104:107], v[48:51]
    v_mfma_f32_16x16x32_bf16 v[52:55], v[92:95], v[68:71], v[52:55]
    ds_read_b64 v[100:101], v143 offset:1280
    ds_read_b64 v[102:103], v143 offset:1288
    s_waitcnt lgkmcnt(11)
    v_mfma_f32_16x16x32_bf16 v[40:43], v[88:91], v[108:111], v[40:43]
    ds_read_b128 v[112:115], v144 offset:1728
    v_mfma_f32_16x16x32_bf16 v[44:47], v[88:91], v[116:119], v[44:47]
    v_mfma_f32_16x16x32_bf16 v[48:51], v[88:91], v[64:67], v[48:51]
    ds_read_b64 v[76:77], v143 offset:768
    ds_read_b64 v[78:79], v143 offset:776
    v_mfma_f32_16x16x32_bf16 v[52:55], v[88:91], v[104:107], v[52:55]
    ds_read_b128 v[92:95], v144 offset:2240
    s_waitcnt lgkmcnt(12)
    v_mfma_f32_16x16x32_bf16 v[40:43], v[80:83], v[72:75], v[40:43]
    s_waitcnt lgkmcnt(9)
    v_mfma_f32_16x16x32_bf16 v[40:43], v[124:127], v[120:123], v[40:43]
    ds_read_b64 v[68:69], v143 offset:256
    ds_read_b64 v[70:71], v143 offset:264
    v_mfma_f32_16x16x32_bf16 v[44:47], v[124:127], v[72:75], v[44:47]
    ds_read_b128 v[108:111], v144 offset:2752
    s_waitcnt lgkmcnt(9)
    v_mfma_f32_16x16x32_bf16 v[40:43], v[96:99], v[84:87], v[40:43]
    v_mfma_f32_16x16x32_bf16 v[44:47], v[96:99], v[120:123], v[44:47]
    ds_read_b64 v[116:117], v143 offset:2880
    ds_read_b64 v[118:119], v143 offset:2888
    v_mfma_f32_16x16x32_bf16 v[48:51], v[96:99], v[72:75], v[48:51]
    ds_read_b128 v[64:67], v144 offset:128
    s_waitcnt lgkmcnt(9)
    v_mfma_f32_16x16x32_bf16 v[40:43], v[100:103], v[112:115], v[40:43]
    v_mfma_f32_16x16x32_bf16 v[44:47], v[100:103], v[84:87], v[44:47]
    ds_read_b64 v[88:89], v143 offset:2368
    ds_read_b64 v[90:91], v143 offset:2376
    v_mfma_f32_16x16x32_bf16 v[48:51], v[100:103], v[120:123], v[48:51]
    ds_read_b128 v[104:107], v144 offset:640
    v_mfma_f32_16x16x32_bf16 v[52:55], v[100:103], v[72:75], v[52:55]
    s_waitcnt lgkmcnt(9)
    v_mfma_f32_16x16x32_bf16 v[40:43], v[76:79], v[92:95], v[40:43]
    ds_read_b64 v[80:81], v143 offset:1856
    ds_read_b64 v[82:83], v143 offset:1864
    v_mfma_f32_16x16x32_bf16 v[44:47], v[76:79], v[112:115], v[44:47]
    ds_read_b128 v[124:127], v144 offset:1152
    v_mfma_f32_16x16x32_bf16 v[48:51], v[76:79], v[84:87], v[48:51]
    v_mfma_f32_16x16x32_bf16 v[52:55], v[76:79], v[120:123], v[52:55]
    ds_read_b64 v[96:97], v143 offset:1344
    ds_read_b64 v[98:99], v143 offset:1352
    s_waitcnt lgkmcnt(11)
    v_mfma_f32_16x16x32_bf16 v[40:43], v[68:71], v[108:111], v[40:43]
    ds_read_b128 v[100:103], v144 offset:1664
    v_mfma_f32_16x16x32_bf16 v[44:47], v[68:71], v[92:95], v[44:47]
    v_mfma_f32_16x16x32_bf16 v[48:51], v[68:71], v[112:115], v[48:51]
    ds_read_b64 v[72:73], v143 offset:832
    ds_read_b64 v[74:75], v143 offset:840
    v_mfma_f32_16x16x32_bf16 v[52:55], v[68:71], v[84:87], v[52:55]
    ds_read_b128 v[76:79], v144 offset:2176
    s_waitcnt lgkmcnt(12)
    v_mfma_f32_16x16x32_bf16 v[40:43], v[116:119], v[64:67], v[40:43]
    s_waitcnt lgkmcnt(9)
    v_mfma_f32_16x16x32_bf16 v[40:43], v[88:91], v[104:107], v[40:43]
    ds_read_b64 v[120:121], v143 offset:320
    ds_read_b64 v[122:123], v143 offset:328
    v_mfma_f32_16x16x32_bf16 v[44:47], v[88:91], v[64:67], v[44:47]
    ds_read_b128 v[108:111], v144 offset:2688
    s_waitcnt lgkmcnt(9)
    v_mfma_f32_16x16x32_bf16 v[40:43], v[80:83], v[124:127], v[40:43]
    v_mfma_f32_16x16x32_bf16 v[44:47], v[80:83], v[104:107], v[44:47]
    ds_read_b64 v[92:93], v143 offset:2944
    ds_read_b64 v[94:95], v143 offset:2952
    v_mfma_f32_16x16x32_bf16 v[48:51], v[80:83], v[64:67], v[48:51]
    ds_read_b128 v[112:115], v144 offset:64
    s_waitcnt lgkmcnt(9)
    v_mfma_f32_16x16x32_bf16 v[40:43], v[96:99], v[100:103], v[40:43]
    v_mfma_f32_16x16x32_bf16 v[44:47], v[96:99], v[124:127], v[44:47]
    ds_read_b64 v[68:69], v143 offset:2432
    ds_read_b64 v[70:71], v143 offset:2440
    v_mfma_f32_16x16x32_bf16 v[48:51], v[96:99], v[104:107], v[48:51]
    ds_read_b128 v[84:87], v144 offset:576
    v_mfma_f32_16x16x32_bf16 v[52:55], v[96:99], v[64:67], v[52:55]
    s_waitcnt lgkmcnt(9)
    v_mfma_f32_16x16x32_bf16 v[40:43], v[72:75], v[76:79], v[40:43]
    ds_read_b64 v[116:117], v143 offset:1920
    ds_read_b64 v[118:119], v143 offset:1928
    v_mfma_f32_16x16x32_bf16 v[44:47], v[72:75], v[100:103], v[44:47]
    ds_read_b128 v[88:91], v144 offset:1088
    v_mfma_f32_16x16x32_bf16 v[48:51], v[72:75], v[124:127], v[48:51]
    v_mfma_f32_16x16x32_bf16 v[52:55], v[72:75], v[104:107], v[52:55]
    ds_read_b64 v[80:81], v143 offset:1408
    ds_read_b64 v[82:83], v143 offset:1416
    s_waitcnt lgkmcnt(11)
    v_mfma_f32_16x16x32_bf16 v[40:43], v[120:123], v[108:111], v[40:43]
    ds_read_b128 v[96:99], v144 offset:1600
    v_mfma_f32_16x16x32_bf16 v[44:47], v[120:123], v[76:79], v[44:47]
    v_mfma_f32_16x16x32_bf16 v[48:51], v[120:123], v[100:103], v[48:51]
    ds_read_b64 v[64:65], v143 offset:896
    ds_read_b64 v[66:67], v143 offset:904
    v_mfma_f32_16x16x32_bf16 v[52:55], v[120:123], v[124:127], v[52:55]
    ds_read_b128 v[72:75], v144 offset:2112
    s_waitcnt lgkmcnt(12)
    v_mfma_f32_16x16x32_bf16 v[40:43], v[92:95], v[112:115], v[40:43]
    s_waitcnt lgkmcnt(9)
    v_mfma_f32_16x16x32_bf16 v[40:43], v[68:71], v[84:87], v[40:43]
    ds_read_b64 v[104:105], v143 offset:384
    ds_read_b64 v[106:107], v143 offset:392
    v_mfma_f32_16x16x32_bf16 v[44:47], v[68:71], v[112:115], v[44:47]
    ds_read_b128 v[108:111], v144 offset:2624
    s_waitcnt lgkmcnt(9)
    v_mfma_f32_16x16x32_bf16 v[40:43], v[116:119], v[88:91], v[40:43]
    v_mfma_f32_16x16x32_bf16 v[44:47], v[116:119], v[84:87], v[44:47]
    ds_read_b64 v[76:77], v143 offset:3008
    ds_read_b64 v[78:79], v143 offset:3016
    v_mfma_f32_16x16x32_bf16 v[48:51], v[116:119], v[112:115], v[48:51]
    ds_read_b128 v[100:103], v144 offset:0
    s_waitcnt lgkmcnt(9)
    v_mfma_f32_16x16x32_bf16 v[40:43], v[80:83], v[96:99], v[40:43]
    v_mfma_f32_16x16x32_bf16 v[44:47], v[80:83], v[88:91], v[44:47]
    ds_read_b64 v[120:121], v143 offset:2496
    ds_read_b64 v[122:123], v143 offset:2504
    v_mfma_f32_16x16x32_bf16 v[48:51], v[80:83], v[84:87], v[48:51]
    ds_read_b128 v[124:127], v144 offset:512
    v_mfma_f32_16x16x32_bf16 v[52:55], v[80:83], v[112:115], v[52:55]
    s_waitcnt lgkmcnt(9)
    v_mfma_f32_16x16x32_bf16 v[40:43], v[64:67], v[72:75], v[40:43]
    ds_read_b64 v[92:93], v143 offset:1984
    ds_read_b64 v[94:95], v143 offset:1992
    v_mfma_f32_16x16x32_bf16 v[44:47], v[64:67], v[96:99], v[44:47]
    ds_read_b128 v[68:71], v144 offset:1024
    v_mfma_f32_16x16x32_bf16 v[48:51], v[64:67], v[88:91], v[48:51]
    v_mfma_f32_16x16x32_bf16 v[52:55], v[64:67], v[84:87], v[52:55]
    ds_read_b64 v[116:117], v143 offset:1472
    ds_read_b64 v[118:119], v143 offset:1480
    s_waitcnt lgkmcnt(11)
    v_mfma_f32_16x16x32_bf16 v[40:43], v[104:107], v[108:111], v[40:43]
    ds_read_b128 v[80:83], v144 offset:1536
    v_mfma_f32_16x16x32_bf16 v[44:47], v[104:107], v[72:75], v[44:47]
    v_mfma_f32_16x16x32_bf16 v[48:51], v[104:107], v[96:99], v[48:51]
    ds_read_b64 v[112:113], v143 offset:960
    ds_read_b64 v[114:115], v143 offset:968
    v_mfma_f32_16x16x32_bf16 v[52:55], v[104:107], v[88:91], v[52:55]
    ds_read_b128 v[64:67], v144 offset:2048
    s_waitcnt lgkmcnt(12)
    v_mfma_f32_16x16x32_bf16 v[40:43], v[76:79], v[100:103], v[40:43]
    s_waitcnt lgkmcnt(9)
    v_mfma_f32_16x16x32_bf16 v[40:43], v[120:123], v[124:127], v[40:43]
    ds_read_b64 v[84:85], v143 offset:448
    ds_read_b64 v[86:87], v143 offset:456
    v_mfma_f32_16x16x32_bf16 v[44:47], v[120:123], v[100:103], v[44:47]
    ds_read_b128 v[108:111], v144 offset:2560
    s_waitcnt lgkmcnt(9)
    v_mfma_f32_16x16x32_bf16 v[40:43], v[92:95], v[68:71], v[40:43]
    v_mfma_f32_16x16x32_bf16 v[44:47], v[92:95], v[124:127], v[44:47]
    v_mfma_f32_16x16x32_bf16 v[48:51], v[92:95], v[100:103], v[48:51]
    s_waitcnt lgkmcnt(6)
    v_mfma_f32_16x16x32_bf16 v[40:43], v[116:119], v[80:83], v[40:43]
    v_mfma_f32_16x16x32_bf16 v[44:47], v[116:119], v[68:71], v[44:47]
    v_mfma_f32_16x16x32_bf16 v[48:51], v[116:119], v[124:127], v[48:51]
    v_mfma_f32_16x16x32_bf16 v[52:55], v[116:119], v[100:103], v[52:55]
    s_waitcnt lgkmcnt(3)
    v_mfma_f32_16x16x32_bf16 v[40:43], v[112:115], v[64:67], v[40:43]
    v_mfma_f32_16x16x32_bf16 v[44:47], v[112:115], v[80:83], v[44:47]
    v_mfma_f32_16x16x32_bf16 v[48:51], v[112:115], v[68:71], v[48:51]
    v_mfma_f32_16x16x32_bf16 v[52:55], v[112:115], v[124:127], v[52:55]
    s_waitcnt lgkmcnt(0)
    v_mfma_f32_16x16x32_bf16 v[40:43], v[84:87], v[108:111], v[40:43]
    v_mfma_f32_16x16x32_bf16 v[44:47], v[84:87], v[64:67], v[44:47]
    v_mfma_f32_16x16x32_bf16 v[48:51], v[84:87], v[80:83], v[48:51]
    v_mfma_f32_16x16x32_bf16 v[52:55], v[84:87], v[68:71], v[52:55]
    s_nop 7
    v_cvt_pk_bf16_f32 v20, v52, v53
    v_cvt_pk_bf16_f32 v21, v54, v55
    ds_write_b64 v145, v[20:21] offset:1024
    v_cvt_pk_bf16_f32 v22, v48, v49
    v_cvt_pk_bf16_f32 v23, v50, v51
    ds_write_b64 v145, v[22:23] offset:1536
    v_cvt_pk_bf16_f32 v24, v44, v45
    v_cvt_pk_bf16_f32 v25, v46, v47
    ds_write_b64 v145, v[24:25] offset:2048
    v_cvt_pk_bf16_f32 v26, v40, v41
    v_cvt_pk_bf16_f32 v27, v42, v43
    ds_write_b64 v145, v[26:27] offset:2560
    s_lshl_b32 s51, 5120, s43
    s_mov_b64 exec, 1
    v_mov_b32 v28, s51
    ds_or_b32 v160, v28
    s_mov_b64 exec, -1
    s_endpgm
L_io:
    v_mul_f32 v40, 0x41000000, v10
    v_mul_f32 v41, 0x41000000, v11
    v_mul_f32 v42, 0x42800000, v10
    v_mul_f32 v43, 0x42800000, v11
    v_mul_f32 v44, 0x43000000, v10
    v_mul_f32 v45, 0x43000000, v11
    v_mul_f32 v46, 0x43400000, v10
    v_mul_f32 v47, 0x43400000, v11
    v_exp_f32 v40, v40
    v_fract_f32 v41, v41
    v_exp_f32 v42, v42
    v_fract_f32 v43, v43
    v_exp_f32 v44, v44
    v_fract_f32 v45, v45
    v_exp_f32 v46, v46
    v_fract_f32 v47, v47
    v_cos_f32 v20, v41
    v_sin_f32 v21, v41
    v_cos_f32 v24, v43
    v_sin_f32 v25, v43
    v_cos_f32 v26, v45
    v_sin_f32 v27, v45
    v_cos_f32 v28, v47
    v_sin_f32 v29, v47
    v_pk_mul_f32 v[20:21], v[20:21], v[40:41] op_sel:[0,0] op_sel_hi:[1,0]
    v_pk_mul_f32 v[24:25], v[24:25], v[42:43] op_sel:[0,0] op_sel_hi:[1,0]
    v_pk_mul_f32 v[26:27], v[26:27], v[44:45] op_sel:[0,0] op_sel_hi:[1,0]
    v_pk_mul_f32 v[28:29], v[28:29], v[46:47] op_sel:[0,0] op_sel_hi:[1,0]
    v_mov_b32 v50, 0x00003f80
    ds_write_b32 v62, v50 offset:16896
    v_cvt_pk_bf16_f32 v51, v20, v21
    ds_write_b32 v62, v51 offset:17424
    v_cvt_pk_bf16_f32 v52, v24, v25
    ds_write_b32 v62, v52 offset:21120
    v_cvt_pk_bf16_f32 v53, v26, v27
    ds_write_b32 v62, v53 offset:25344
    v_cvt_pk_bf16_f32 v54, v28, v29
    ds_write_b32 v62, v54 offset:29568
    v_pk_mul_f32 v[42:43], v[24:25], v[20:21] op_sel:[0,0] op_sel_hi:[0,1]
    v_pk_mul_f32 v[44:45], v[26:27], v[20:21] op_sel:[0,0] op_sel_hi:[0,1]
    v_pk_mul_f32 v[46:47], v[28:29], v[20:21] op_sel:[0,0] op_sel_hi:[0,1]
    v_pk_fma_f32 v[24:25], v[24:25], v[20:21], v[42:43] op_sel:[1,1,0] op_sel_hi:[1,0,1] neg_lo:[1,0,0]
    v_pk_fma_f32 v[26:27], v[26:27], v[20:21], v[44:45] op_sel:[1,1,0] op_sel_hi:[1,0,1] neg_lo:[1,0,0]
    v_pk_fma_f32 v[28:29], v[28:29], v[20:21], v[46:47] op_sel:[1,1,0] op_sel_hi:[1,0,1] neg_lo:[1,0,0]
    v_cvt_pk_bf16_f32 v51, v24, v25
    ds_write_b32 v62, v51 offset:21648
    v_cvt_pk_bf16_f32 v52, v26, v27
    ds_write_b32 v62, v52 offset:25872
    v_cvt_pk_bf16_f32 v53, v28, v29
    ds_write_b32 v62, v53 offset:30096
    v_pk_mul_f32 v[40:41], v[20:21], v[20:21] op_sel:[0,0] op_sel_hi:[0,1]
    v_pk_mul_f32 v[42:43], v[24:25], v[20:21] op_sel:[0,0] op_sel_hi:[0,1]
    v_pk_mul_f32 v[44:45], v[26:27], v[20:21] op_sel:[0,0] op_sel_hi:[0,1]
    v_pk_mul_f32 v[46:47], v[28:29], v[20:21] op_sel:[0,0] op_sel_hi:[0,1]
    v_pk_fma_f32 v[22:23], v[20:21], v[20:21], v[40:41] op_sel:[1,1,0] op_sel_hi:[1,0,1] neg_lo:[1,0,0]
    v_pk_fma_f32 v[24:25], v[24:25], v[20:21], v[42:43] op_sel:[1,1,0] op_sel_hi:[1,0,1] neg_lo:[1,0,0]
    v_pk_fma_f32 v[26:27], v[26:27], v[20:21], v[44:45] op_sel:[1,1,0] op_sel_hi:[1,0,1] neg_lo:[1,0,0]
    v_pk_fma_f32 v[28:29], v[28:29], v[20:21], v[46:47] op_sel:[1,1,0] op_sel_hi:[1,0,1] neg_lo:[1,0,0]
    v_cvt_pk_bf16_f32 v50, v22, v23
    ds_write_b32 v62, v50 offset:17952
    v_cvt_pk_bf16_f32 v51, v24, v25
    ds_write_b32 v62, v51 offset:22176
    v_cvt_pk_bf16_f32 v52, v26, v27
    ds_write_b32 v62, v52 offset:26400
    v_cvt_pk_bf16_f32 v53, v28, v29
    ds_write_b32 v62, v53 offset:30624
    v_pk_mul_f32 v[40:41], v[22:23], v[20:21] op_sel:[0,0] op_sel_hi:[0,1]
    v_pk_mul_f32 v[42:43], v[24:25], v[20:21] op_sel:[0,0] op_sel_hi:[0,1]
    v_pk_mul_f32 v[44:45], v[26:27], v[20:21] op_sel:[0,0] op_sel_hi:[0,1]
    v_pk_mul_f32 v[46:47], v[28:29], v[20:21] op_sel:[0,0] op_sel_hi:[0,1]
    v_pk_fma_f32 v[22:23], v[22:23], v[20:21], v[40:41] op_sel:[1,1,0] op_sel_hi:[1,0,1] neg_lo:[1,0,0]
    v_pk_fma_f32 v[24:25], v[24:25], v[20:21], v[42:43] op_sel:[1,1,0] op_sel_hi:[1,0,1] neg_lo:[1,0,0]
    v_pk_fma_f32 v[26:27], v[26:27], v[20:21], v[44:45] op_sel:[1,1,0] op_sel_hi:[1,0,1] neg_lo:[1,0,0]
    v_pk_fma_f32 v[28:29], v[28:29], v[20:21], v[46:47] op_sel:[1,1,0] op_sel_hi:[1,0,1] neg_lo:[1,0,0]
    v_cvt_pk_bf16_f32 v50, v22, v23
    ds_write_b32 v62, v50 offset:18480
    v_cvt_pk_bf16_f32 v51, v24, v25
    ds_write_b32 v62, v51 offset:22704
    v_cvt_pk_bf16_f32 v52, v26, v27
    ds_write_b32 v62, v52 offset:26928
    v_cvt_pk_bf16_f32 v53, v28, v29
    ds_write_b32 v62, v53 offset:31152
    v_pk_mul_f32 v[40:41], v[22:23], v[20:21] op_sel:[0,0] op_sel_hi:[0,1]
    v_pk_mul_f32 v[42:43], v[24:25], v[20:21] op_sel:[0,0] op_sel_hi:[0,1]
    v_pk_mul_f32 v[44:45], v[26:27], v[20:21] op_sel:[0,0] op_sel_hi:[0,1]
    v_pk_mul_f32 v[46:47], v[28:29], v[20:21] op_sel:[0,0] op_sel_hi:[0,1]
    v_pk_fma_f32 v[22:23], v[22:23], v[20:21], v[40:41] op_sel:[1,1,0] op_sel_hi:[1,0,1] neg_lo:[1,0,0]
    v_pk_fma_f32 v[24:25], v[24:25], v[20:21], v[42:43] op_sel:[1,1,0] op_sel_hi:[1,0,1] neg_lo:[1,0,0]
    v_pk_fma_f32 v[26:27], v[26:27], v[20:21], v[44:45] op_sel:[1,1,0] op_sel_hi:[1,0,1] neg_lo:[1,0,0]
    v_pk_fma_f32 v[28:29], v[28:29], v[20:21], v[46:47] op_sel:[1,1,0] op_sel_hi:[1,0,1] neg_lo:[1,0,0]
    v_cvt_pk_bf16_f32 v50, v22, v23
    ds_write_b32 v62, v50 offset:19008
    v_cvt_pk_bf16_f32 v51, v24, v25
    ds_write_b32 v62, v51 offset:23232
    v_cvt_pk_bf16_f32 v52, v26, v27
    ds_write_b32 v62, v52 offset:27456
    v_cvt_pk_bf16_f32 v53, v28, v29
    ds_write_b32 v62, v53 offset:31680
    v_pk_mul_f32 v[40:41], v[22:23], v[20:21] op_sel:[0,0] op_sel_hi:[0,1]
    v_pk_mul_f32 v[42:43], v[24:25], v[20:21] op_sel:[0,0] op_sel_hi:[0,1]
    v_pk_mul_f32 v[44:45], v[26:27], v[20:21] op_sel:[0,0] op_sel_hi:[0,1]
    v_pk_mul_f32 v[46:47], v[28:29], v[20:21] op_sel:[0,0] op_sel_hi:[0,1]
    v_pk_fma_f32 v[22:23], v[22:23], v[20:21], v[40:41] op_sel:[1,1,0] op_sel_hi:[1,0,1] neg_lo:[1,0,0]
    v_pk_fma_f32 v[24:25], v[24:25], v[20:21], v[42:43] op_sel:[1,1,0] op_sel_hi:[1,0,1] neg_lo:[1,0,0]
    v_pk_fma_f32 v[26:27], v[26:27], v[20:21], v[44:45] op_sel:[1,1,0] op_sel_hi:[1,0,1] neg_lo:[1,0,0]
    v_pk_fma_f32 v[28:29], v[28:29], v[20:21], v[46:47] op_sel:[1,1,0] op_sel_hi:[1,0,1] neg_lo:[1,0,0]
    v_cvt_pk_bf16_f32 v50, v22, v23
    ds_write_b32 v62, v50 offset:19536
    v_cvt_pk_bf16_f32 v51, v24, v25
    ds_write_b32 v62, v51 offset:23760
    v_cvt_pk_bf16_f32 v52, v26, v27
    ds_write_b32 v62, v52 offset:27984
    v_cvt_pk_bf16_f32 v53, v28, v29
    ds_write_b32 v62, v53 offset:32208
    v_pk_mul_f32 v[40:41], v[22:23], v[20:21] op_sel:[0,0] op_sel_hi:[0,1]
    v_pk_mul_f32 v[42:43], v[24:25], v[20:21] op_sel:[0,0] op_sel_hi:[0,1]
    v_pk_mul_f32 v[44:45], v[26:27], v[20:21] op_sel:[0,0] op_sel_hi:[0,1]
    v_pk_mul_f32 v[46:47], v[28:29], v[20:21] op_sel:[0,0] op_sel_hi:[0,1]
    v_pk_fma_f32 v[22:23], v[22:23], v[20:21], v[40:41] op_sel:[1,1,0] op_sel_hi:[1,0,1] neg_lo:[1,0,0]
    v_pk_fma_f32 v[24:25], v[24:25], v[20:21], v[42:43] op_sel:[1,1,0] op_sel_hi:[1,0,1] neg_lo:[1,0,0]
    v_pk_fma_f32 v[26:27], v[26:27], v[20:21], v[44:45] op_sel:[1,1,0] op_sel_hi:[1,0,1] neg_lo:[1,0,0]
    v_pk_fma_f32 v[28:29], v[28:29], v[20:21], v[46:47] op_sel:[1,1,0] op_sel_hi:[1,0,1] neg_lo:[1,0,0]
    v_cvt_pk_bf16_f32 v50, v22, v23
    ds_write_b32 v62, v50 offset:20064
    v_cvt_pk_bf16_f32 v51, v24, v25
    ds_write_b32 v62, v51 offset:24288
    v_cvt_pk_bf16_f32 v52, v26, v27
    ds_write_b32 v62, v52 offset:28512
    v_cvt_pk_bf16_f32 v53, v28, v29
    ds_write_b32 v62, v53 offset:32736
    v_pk_mul_f32 v[40:41], v[22:23], v[20:21] op_sel:[0,0] op_sel_hi:[0,1]
    v_pk_mul_f32 v[42:43], v[24:25], v[20:21] op_sel:[0,0] op_sel_hi:[0,1]
    v_pk_mul_f32 v[44:45], v[26:27], v[20:21] op_sel:[0,0] op_sel_hi:[0,1]
    v_pk_mul_f32 v[46:47], v[28:29], v[20:21] op_sel:[0,0] op_sel_hi:[0,1]
    v_pk_fma_f32 v[22:23], v[22:23], v[20:21], v[40:41] op_sel:[1,1,0] op_sel_hi:[1,0,1] neg_lo:[1,0,0]
    v_pk_fma_f32 v[24:25], v[24:25], v[20:21], v[42:43] op_sel:[1,1,0] op_sel_hi:[1,0,1] neg_lo:[1,0,0]
    v_pk_fma_f32 v[26:27], v[26:27], v[20:21], v[44:45] op_sel:[1,1,0] op_sel_hi:[1,0,1] neg_lo:[1,0,0]
    v_pk_fma_f32 v[28:29], v[28:29], v[20:21], v[46:47] op_sel:[1,1,0] op_sel_hi:[1,0,1] neg_lo:[1,0,0]
    v_cvt_pk_bf16_f32 v50, v22, v23
    ds_write_b32 v62, v50 offset:20592
    v_cvt_pk_bf16_f32 v51, v24, v25
    ds_write_b32 v62, v51 offset:24816
    v_cvt_pk_bf16_f32 v52, v26, v27
    ds_write_b32 v62, v52 offset:29040
    v_cvt_pk_bf16_f32 v53, v28, v29
    ds_write_b32 v62, v53 offset:33264
    s_lshl_b32 s51, 262144, s4
    s_mov_b64 exec, 1
    v_mov_b32 v50, s51
    ds_or_b32 v160, v50
    s_mov_b64 exec, -1
    s_sub_u32 s53, s4, 4
    s_lshl_b32 s54, s49, 16
    s_and_b32 s55, s49, s52
    s_lshl_b32 s58, 1, s53
    v_mov_b32 v7, s58
    s_setprio 2
    global_load_dwordx4 v[112:115], v138, s[40:41] sc1
    global_load_dwordx4 v[116:119], v138, s[40:41] offset:128 sc1
    global_load_dwordx4 v[120:123], v138, s[40:41] offset:256 sc1
    global_load_dwordx4 v[124:127], v137, s[40:41] offset:-4096 sc1
    global_load_dwordx4 v[128:131], v137, s[40:41] sc1
    global_load_dwordx4 v[132:135], v140, s[40:41] sc1
    s_mov_b64 exec, 1
    v_mov_b32 v56, 256
    ds_add_u32 v160, v56 offset:16
    s_mov_b64 exec, -1
    s_mov_b32 s59, 0
L_io_poll_loop:
    s_add_u32 s59, s59, 1
    s_waitcnt vmcnt(3)
    v_cmp_ne_u32 vcc, s5, v115
    v_cmp_ne_u32 s[60:61], s5, v119
    v_cmp_ne_u32 s[62:63], s5, v123
    v_lshlrev_b32 v40, 16, v112
    v_and_b32 v41, s52, v112
    v_lshlrev_b32 v42, 16, v113
    v_and_b32 v43, s52, v113
    v_lshlrev_b32 v44, 16, v114
    v_and_b32 v45, s52, v114
    v_lshlrev_b32 v46, 16, v116
    v_and_b32 v47, s52, v116
    v_lshlrev_b32 v48, 16, v117
    v_and_b32 v49, s52, v117
    v_lshlrev_b32 v50, 16, v118
    v_and_b32 v51, s52, v118
    v_lshlrev_b32 v52, 16, v120
    v_and_b32 v53, s52, v120
    v_lshlrev_b32 v54, 16, v121
    v_and_b32 v55, s52, v121
    s_or_b64 vcc, vcc, s[60:61]
    s_or_b64 vcc, vcc, s[62:63]
    s_waitcnt vmcnt(0)
    v_cmp_ne_u32 s[60:61], s5, v127
    v_cmp_ne_u32 s[62:63], s5, v131
    s_or_b64 vcc, vcc, s[60:61]
    v_cmp_ne_u32 s[60:61], s5, v135
    s_or_b64 vcc, vcc, s[62:63]
    s_or_b64 vcc, vcc, s[60:61]
    s_and_b64 exec, exec, vcc
    s_cbranch_execz L_io_poll_done
    s_sleep 2
    global_load_dwordx4 v[112:115], v138, s[40:41] sc1
    global_load_dwordx4 v[116:119], v138, s[40:41] offset:128 sc1
    global_load_dwordx4 v[120:123], v138, s[40:41] offset:256 sc1
    global_load_dwordx4 v[124:127], v137, s[40:41] offset:-4096 sc1
    global_load_dwordx4 v[128:131], v137, s[40:41] sc1
    global_load_dwordx4 v[132:135], v140, s[40:41] sc1
    s_cmp_lt_u32 s59, 65536
    s_cbranch_scc1 L_io_poll_loop
    s_waitcnt vmcnt(0)
L_io_poll_done:
    s_mov_b64 exec, -1
    v_and_b32 v144, s52, v124
    v_lshlrev_b32 v80, 16, v124
    v_and_b32 v146, s52, v125
    v_lshlrev_b32 v82, 16, v125
    v_and_b32 v148, s52, v126
    v_lshlrev_b32 v84, 16, v126
    v_and_b32 v150, s52, v128
    v_lshlrev_b32 v86, 16, v128
    v_and_b32 v152, s52, v129
    v_lshlrev_b32 v88, 16, v129
    v_and_b32 v154, s52, v130
    v_lshlrev_b32 v90, 16, v130
    v_and_b32 v156, s52, v132
    v_lshlrev_b32 v92, 16, v132
    v_and_b32 v158, s52, v133
    v_lshlrev_b32 v94, 16, v133
    v_rcp_f32 v144, v144
    v_pk_add_f32 v[96:97], v[40:41], v[80:81] op_sel_hi:[1,0] neg_lo:[0,1] neg_hi:[0,1]
    v_rcp_f32 v146, v146
    v_pk_add_f32 v[98:99], v[42:43], v[82:83] op_sel_hi:[1,0] neg_lo:[0,1] neg_hi:[0,1]
    v_rcp_f32 v148, v148
    v_pk_add_f32 v[100:101], v[44:45], v[84:85] op_sel_hi:[1,0] neg_lo:[0,1] neg_hi:[0,1]
    v_rcp_f32 v150, v150
    v_pk_add_f32 v[102:103], v[46:47], v[86:87] op_sel_hi:[1,0] neg_lo:[0,1] neg_hi:[0,1]
    v_rcp_f32 v152, v152
    v_pk_add_f32 v[104:105], v[48:49], v[88:89] op_sel_hi:[1,0] neg_lo:[0,1] neg_hi:[0,1]
    v_rcp_f32 v154, v154
    v_pk_add_f32 v[106:107], v[50:51], v[90:91] op_sel_hi:[1,0] neg_lo:[0,1] neg_hi:[0,1]
    v_rcp_f32 v156, v156
    v_pk_add_f32 v[108:109], v[52:53], v[92:93] op_sel_hi:[1,0] neg_lo:[0,1] neg_hi:[0,1]
    v_rcp_f32 v158, v158
    v_pk_add_f32 v[110:111], v[54:55], v[94:95] op_sel_hi:[1,0] neg_lo:[0,1] neg_hi:[0,1]
    v_pk_mul_f32 v[96:97], v[96:97], v[144:145] op_sel_hi:[1,0]
    v_pk_mul_f32 v[98:99], v[98:99], v[146:147] op_sel_hi:[1,0]
    v_pk_mul_f32 v[100:101], v[100:101], v[148:149] op_sel_hi:[1,0]
    v_pk_mul_f32 v[102:103], v[102:103], v[150:151] op_sel_hi:[1,0]
    v_pk_mul_f32 v[104:105], v[104:105], v[152:153] op_sel_hi:[1,0]
    v_pk_mul_f32 v[106:107], v[106:107], v[154:155] op_sel_hi:[1,0]
    v_pk_mul_f32 v[108:109], v[108:109], v[156:157] op_sel_hi:[1,0]
    v_pk_mul_f32 v[110:111], v[110:111], v[158:159] op_sel_hi:[1,0]
    v_cvt_pk_bf16_f32 v64, v110, v108
    v_cvt_pk_bf16_f32 v65, v106, v104
    v_cvt_pk_bf16_f32 v66, v102, v100
    v_cvt_pk_bf16_f32 v67, v98, v96
    ds_write_b128 v139, v[64:67] offset:0
    v_cvt_pk_bf16_f32 v68, v111, v109
    v_cvt_pk_bf16_f32 v69, v107, v105
    v_cvt_pk_bf16_f32 v70, v103, v101
    v_cvt_pk_bf16_f32 v71, v99, v97
    ds_write_b128 v139, v[68:71] offset:4608
    s_mov_b64 exec, 1
    ds_or_b32 v160, v7
    s_mov_b64 exec, -1
    s_setprio 0
    v_and_b32 v80, s52, v67
    v_and_b32 v81, s52, v71
    v_lshlrev_b32 v82, 16, v67
    v_lshlrev_b32 v83, 16, v71
    v_and_b32 v84, s52, v66
    v_and_b32 v85, s52, v70
    v_lshlrev_b32 v86, 16, v66
    v_lshlrev_b32 v87, 16, v70
    v_and_b32 v88, s52, v65
    v_and_b32 v89, s52, v69
    v_lshlrev_b32 v90, 16, v65
    v_lshlrev_b32 v91, 16, v69
    v_and_b32 v92, s52, v64
    v_and_b32 v93, s52, v68
    v_lshlrev_b32 v94, 16, v64
    v_lshlrev_b32 v95, 16, v68
    v_pk_mul_f32 v[96:97], v[80:81], s[54:55]
    v_pk_add_f32 v[40:41], v[40:41], v[80:81]
    v_pk_mul_f32 v[98:99], v[82:83], s[54:55]
    v_pk_add_f32 v[42:43], v[42:43], v[82:83]
    v_pk_mul_f32 v[100:101], v[84:85], s[54:55]
    v_pk_add_f32 v[44:45], v[44:45], v[84:85]
    v_pk_mul_f32 v[102:103], v[86:87], s[54:55]
    v_pk_add_f32 v[46:47], v[46:47], v[86:87]
    v_pk_mul_f32 v[104:105], v[88:89], s[54:55]
    v_pk_add_f32 v[48:49], v[48:49], v[88:89]
    v_pk_mul_f32 v[106:107], v[90:91], s[54:55]
    v_pk_add_f32 v[50:51], v[50:51], v[90:91]
    v_pk_mul_f32 v[108:109], v[92:93], s[54:55]
    v_pk_add_f32 v[52:53], v[52:53], v[92:93]
    v_pk_mul_f32 v[110:111], v[94:95], s[54:55]
    v_pk_add_f32 v[54:55], v[54:55], v[94:95]
    v_cvt_pk_bf16_f32 v20, v96, v97
    v_cvt_pk_bf16_f32 v21, v98, v99
    v_cvt_pk_bf16_f32 v22, v100, v101
    v_cvt_pk_bf16_f32 v23, v102, v103
    v_cvt_pk_bf16_f32 v24, v104, v105
    v_cvt_pk_bf16_f32 v25, v106, v107
    v_cvt_pk_bf16_f32 v26, v108, v109
    v_cvt_pk_bf16_f32 v27, v110, v111
    v_lshlrev_b32 v96, 16, v20
    v_and_b32 v97, s52, v20
    v_lshlrev_b32 v98, 16, v21
    v_and_b32 v99, s52, v21
    v_lshlrev_b32 v100, 16, v22
    v_and_b32 v101, s52, v22
    v_lshlrev_b32 v102, 16, v23
    v_and_b32 v103, s52, v23
    v_lshlrev_b32 v104, 16, v24
    v_and_b32 v105, s52, v24
    v_lshlrev_b32 v106, 16, v25
    v_and_b32 v107, s52, v25
    v_lshlrev_b32 v108, 16, v26
    v_and_b32 v109, s52, v26
    v_lshlrev_b32 v110, 16, v27
    v_and_b32 v111, s52, v27
    v_pk_add_f32 v[40:41], v[40:41], v[96:97]
    v_pk_add_f32 v[42:43], v[42:43], v[98:99]
    v_pk_add_f32 v[44:45], v[44:45], v[100:101]
    v_pk_add_f32 v[46:47], v[46:47], v[102:103]
    v_pk_add_f32 v[48:49], v[48:49], v[104:105]
    v_pk_add_f32 v[50:51], v[50:51], v[106:107]
    v_pk_add_f32 v[52:53], v[52:53], v[108:109]
    v_pk_add_f32 v[54:55], v[54:55], v[110:111]
    s_not_b32 s7, s5
    v_mov_b32 v23, s7
    v_mov_b32 v27, s7
    v_mov_b32 v31, s7
    s_lshl_b32 s7, s53, 1
    s_lshl_b32 s51, 768, s7
    s_setprio 0
L_ws_5:
    ds_read_b32 v7, v160
    s_sub_u32 s88, s88, 1
    s_cbranch_scc1 L_exit
    s_waitcnt lgkmcnt(0)
    v_readfirstlane_b32 s7, v7
    s_and_b32 s7, s7, s51
    s_cmp_eq_u32 s7, s51
    s_cbranch_scc0 L_ws_5
    s_setprio 2
    ds_read_b128 v[64:67], v139 offset:8704
    ds_read_b128 v[68:71], v139 offset:12800
    s_waitcnt lgkmcnt(0)
    v_lshlrev_b32 v80, 16, v64
    v_lshlrev_b32 v81, 16, v68
    v_and_b32 v82, s52, v64
    v_and_b32 v83, s52, v68
    v_lshlrev_b32 v84, 16, v65
    v_lshlrev_b32 v85, 16, v69
    v_pk_add_f32 v[80:81], v[80:81], v[40:41]
    v_pk_add_f32 v[82:83], v[82:83], v[42:43]
    v_pk_add_f32 v[84:85], v[84:85], v[44:45]
    v_cvt_pk_bf16_f32 v20, v80, v81
    v_cvt_pk_bf16_f32 v21, v82, v83
    v_cvt_pk_bf16_f32 v22, v84, v85
    global_store_dwordx4 v138, v[20:23], s[40:41] offset:0 sc1
    v_and_b32 v86, s52, v65
    v_and_b32 v87, s52, v69
    v_lshlrev_b32 v88, 16, v66
    v_lshlrev_b32 v89, 16, v70
    v_and_b32 v90, s52, v66
    v_and_b32 v91, s52, v70
    v_pk_add_f32 v[86:87], v[86:87], v[46:47]
    v_pk_add_f32 v[88:89], v[88:89], v[48:49]
    v_pk_add_f32 v[90:91], v[90:91], v[50:51]
    v_cvt_pk_bf16_f32 v24, v86, v87
    v_cvt_pk_bf16_f32 v25, v88, v89
    v_cvt_pk_bf16_f32 v26, v90, v91
    global_store_dwordx4 v138, v[24:27], s[40:41] offset:128 sc1
    v_lshlrev_b32 v92, 16, v67
    v_lshlrev_b32 v93, 16, v71
    v_and_b32 v94, s52, v67
    v_and_b32 v95, s52, v71
    v_pk_add_f32 v[92:93], v[92:93], v[52:53]
    v_pk_add_f32 v[94:95], v[94:95], v[54:55]
    v_cvt_pk_bf16_f32 v28, v92, v93
    v_cvt_pk_bf16_f32 v29, v94, v95
    global_store_dwordx4 v138, v[28:31], s[40:41] offset:256 sc1
    s_setprio 0
L_ws_6:
    ds_read_b32 v7, v160
    s_sub_u32 s88, s88, 1
    s_cbranch_scc1 L_exit
    s_waitcnt lgkmcnt(0)
    v_readfirstlane_b32 s7, v7
    s_and_b32 s7, s7, 65536
    s_cmp_eq_u32 s7, 65536
    s_cbranch_scc0 L_ws_6
    ds_read_b32 v7, v160 offset:4
    s_waitcnt lgkmcnt(0)
    v_readfirstlane_b32 s60, v7
    s_lshr_b32 s7, s60, 9
    s_cmp_eq_u32 s7, s53
    s_cbranch_scc0 L_io_end
    s_lshr_b32 s61, s60, 3
    s_and_b32 s60, s60, 7
    s_lshl_b64 exec, 1, s61
    v_mov_b32 v7, 131072
    s_cmp_eq_u32 s60, 0
    s_cbranch_scc0 L_t1_7
    ds_write_b64 v160, v[80:81] offset:8
L_t1_7:
    s_cmp_eq_u32 s60, 1
    s_cbranch_scc0 L_t1_8
    ds_write_b64 v160, v[82:83] offset:8
L_t1_8:
    s_cmp_eq_u32 s60, 2
    s_cbranch_scc0 L_t1_9
    ds_write_b64 v160, v[84:85] offset:8
L_t1_9:
    s_cmp_eq_u32 s60, 3
    s_cbranch_scc0 L_t1_10
    ds_write_b64 v160, v[86:87] offset:8
L_t1_10:
    s_cmp_eq_u32 s60, 4
    s_cbranch_scc0 L_t1_11
    ds_write_b64 v160, v[88:89] offset:8
L_t1_11:
    s_cmp_eq_u32 s60, 5
    s_cbranch_scc0 L_t1_12
    ds_write_b64 v160, v[90:91] offset:8
L_t1_12:
    s_cmp_eq_u32 s60, 6
    s_cbranch_scc0 L_t1_13
    ds_write_b64 v160, v[92:93] offset:8
L_t1_13:
    s_cmp_eq_u32 s60, 7
    s_cbranch_scc0 L_t1_14
    ds_write_b64 v160, v[94:95] offset:8
L_t1_14:
    ds_or_b32 v160, v7
    s_mov_b64 exec, -1
L_io_end:
    s_endpgm
L_tr:
    s_mov_b32 s88, 0x400000
    s_mul_i32 s7, s51, 393216
    s_mul_i32 s53, s50, 384
    s_add_u32 s7, s7, s53
    s_add_u32 s7, s7, 524288
    s_mov_b32 s53, 49152
    v_lshl_add_u32 v8, v6, 4, s7
    v_mad_u32_u24 v8, v7, s53, v8
    v_add_u32 v9, 12288, v8
    v_add_u32 v10, 24576, v8
    v_add_u32 v11, 36864, v8
    s_waitcnt lgkmcnt(0)
    s_mul_i32 s5, s6, 0x9E3779B1
    s_add_u32 s5, s5, 0x7F4A7C15
    s_mov_b64 exec, 1
    v_mov_b32 v13, 16
    ds_add_u32 v160, v13 offset:16
    s_mov_b64 exec, -1
    v_mov_b32 v19, s5
    v_mov_b32 v23, s5
    v_mov_b32 v27, s5
    v_mov_b32 v31, s5
    v_mov_b32 v35, s5
    v_mov_b32 v39, s5
    v_mov_b32 v43, s5
    v_mov_b32 v47, s5
    v_mov_b32 v51, s5
    v_mov_b32 v55, s5
    v_mov_b32 v59, s5
    v_mov_b32 v63, s5
    s_setprio 3
    s_waitcnt vmcnt(0)
    v_mov_b32 v16, v64
    v_mov_b32 v17, v68
    v_mov_b32 v18, v72
    global_store_dwordx4 v8, v[16:19], s[40:41] offset:0 sc1
    v_mov_b32 v28, v65
    v_mov_b32 v29, v69
    v_mov_b32 v30, v73
    global_store_dwordx4 v9, v[28:31], s[40:41] offset:0 sc1
    v_mov_b32 v40, v66
    v_mov_b32 v41, v70
    v_mov_b32 v42, v74
    global_store_dwordx4 v10, v[40:43], s[40:41] offset:0 sc1
    v_mov_b32 v52, v67
    v_mov_b32 v53, v71
    v_mov_b32 v54, v75
    global_store_dwordx4 v11, v[52:55], s[40:41] offset:0 sc1
    v_mov_b32 v20, v76
    v_mov_b32 v21, v80
    v_mov_b32 v22, v84
    global_store_dwordx4 v8, v[20:23], s[40:41] offset:128 sc1
    v_mov_b32 v32, v77
    v_mov_b32 v33, v81
    v_mov_b32 v34, v85
    global_store_dwordx4 v9, v[32:35], s[40:41] offset:128 sc1
    v_mov_b32 v44, v78
    v_mov_b32 v45, v82
    v_mov_b32 v46, v86
    global_store_dwordx4 v10, v[44:47], s[40:41] offset:128 sc1
    v_mov_b32 v56, v79
    v_mov_b32 v57, v83
    v_mov_b32 v58, v87
    global_store_dwordx4 v11, v[56:59], s[40:41] offset:128 sc1
    v_mov_b32 v24, v88
    v_mov_b32 v25, v92
    global_store_dwordx4 v8, v[24:27], s[40:41] offset:256 sc1
    v_mov_b32 v36, v89
    v_mov_b32 v37, v93
    global_store_dwordx4 v9, v[36:39], s[40:41] offset:256 sc1
    v_mov_b32 v48, v90
    v_mov_b32 v49, v94
    global_store_dwordx4 v10, v[48:51], s[40:41] offset:256 sc1
    v_mov_b32 v60, v91
    v_mov_b32 v61, v95
    global_store_dwordx4 v11, v[60:63], s[40:41] offset:256 sc1
    s_mov_b64 exec, 1
    v_mov_b32 v13, 64
    ds_add_u32 v160, v13 offset:16
    s_mov_b64 exec, -1
    s_setprio 0
    s_not_b32 s5, s5
    s_lshr_b32 s7, s50, 3
    s_lshl_b32 s7, s7, 1
    s_lshl_b32 s53, 768, s7
    s_or_b32 s53, s53, 65536
L_ws_15:
    s_sleep 2
    ds_read_b32 v13, v160
    s_sub_u32 s88, s88, 1
    s_cbranch_scc1 L_exit
    s_waitcnt lgkmcnt(0)
    v_readfirstlane_b32 s7, v13
    s_and_b32 s7, s7, s53
    s_cmp_eq_u32 s7, s53
    s_cbranch_scc0 L_ws_15
    ds_read_b32 v13, v160 offset:4
    s_waitcnt lgkmcnt(0)
    v_readfirstlane_b32 s60, v13
    s_lshr_b32 s7, s60, 6
    s_bfe_u32 s61, s60, 0x30003
    s_and_b32 s60, s60, 7
    s_cmp_eq_u32 s7, s50
    s_cselect_b32 s60, s60, 8
    s_mov_b32 s62, 0x01010101
    s_mov_b32 s63, 0x01010101
    s_lshl_b64 s[62:63], s[62:63], s61
    s_not_b64 s[62:63], s[62:63]
    s_setprio 3
    s_sleep 22
    s_mov_b32 s59, 0
L_ot_loop:
    global_load_dwordx4 v[16:19], v8, s[40:41] offset:0 sc1
    global_load_dwordx4 v[20:23], v8, s[40:41] offset:128 sc1
    global_load_dwordx4 v[24:27], v8, s[40:41] offset:256 sc1
    global_load_dwordx4 v[28:31], v9, s[40:41] offset:0 sc1
    global_load_dwordx4 v[32:35], v9, s[40:41] offset:128 sc1
    global_load_dwordx4 v[36:39], v9, s[40:41] offset:256 sc1
    global_load_dwordx4 v[40:43], v10, s[40:41] offset:0 sc1
    global_load_dwordx4 v[44:47], v10, s[40:41] offset:128 sc1
    global_load_dwordx4 v[48:51], v10, s[40:41] offset:256 sc1
    global_load_dwordx4 v[52:55], v11, s[40:41] offset:0 sc1
    global_load_dwordx4 v[56:59], v11, s[40:41] offset:128 sc1
    global_load_dwordx4 v[60:63], v11, s[40:41] offset:256 sc1
    s_add_u32 s59, s59, 1
    s_waitcnt vmcnt(0)
    v_cmp_ne_u32 vcc, s5, v19
    v_cmp_ne_u32 s[56:57], s5, v23
    s_or_b64 vcc, vcc, s[56:57]
    v_cmp_ne_u32 s[56:57], s5, v27
    s_or_b64 vcc, vcc, s[56:57]
    v_cmp_ne_u32 s[56:57], s5, v31
    s_or_b64 vcc, vcc, s[56:57]
    v_cmp_ne_u32 s[56:57], s5, v35
    s_or_b64 vcc, vcc, s[56:57]
    v_cmp_ne_u32 s[56:57], s5, v39
    s_or_b64 vcc, vcc, s[56:57]
    v_cmp_ne_u32 s[56:57], s5, v43
    s_or_b64 vcc, vcc, s[56:57]
    v_cmp_ne_u32 s[56:57], s5, v47
    s_or_b64 vcc, vcc, s[56:57]
    v_cmp_ne_u32 s[56:57], s5, v51
    s_or_b64 vcc, vcc, s[56:57]
    v_cmp_ne_u32 s[56:57], s5, v55
    s_or_b64 vcc, vcc, s[56:57]
    v_cmp_ne_u32 s[56:57], s5, v59
    s_or_b64 vcc, vcc, s[56:57]
    v_cmp_ne_u32 s[56:57], s5, v63
    s_or_b64 vcc, vcc, s[56:57]
    s_and_b64 exec, exec, vcc
    s_cbranch_execz L_ot_done
    s_sleep 2
    s_cmp_lt_u32 s59, 65536
    s_cbranch_scc1 L_ot_loop
L_ot_done:
    s_mov_b64 exec, -1
    v_mov_b32 v64, v16
    v_mov_b32 v65, v28
    v_mov_b32 v66, v40
    v_mov_b32 v67, v52
    s_cmp_eq_u32 s60, 0
    s_cselect_b64 exec, s[62:63], -1
    global_store_dwordx4 v4, v[64:67], s[36:37] offset:0
    s_mov_b64 exec, -1
    v_mov_b32 v68, v17
    v_mov_b32 v69, v29
    v_mov_b32 v70, v41
    v_mov_b32 v71, v53
    s_cmp_eq_u32 s60, 1
    s_cselect_b64 exec, s[62:63], -1
    global_store_dwordx4 v4, v[68:71], s[36:37] offset:1024
    s_mov_b64 exec, -1
    v_mov_b32 v72, v18
    v_mov_b32 v73, v30
    v_mov_b32 v74, v42
    v_mov_b32 v75, v54
    s_cmp_eq_u32 s60, 2
    s_cselect_b64 exec, s[62:63], -1
    global_store_dwordx4 v4, v[72:75], s[36:37] offset:2048
    s_mov_b64 exec, -1
    v_mov_b32 v76, v20
    v_mov_b32 v77, v32
    v_mov_b32 v78, v44
    v_mov_b32 v79, v56
    s_cmp_eq_u32 s60, 3
    s_cselect_b64 exec, s[62:63], -1
    global_store_dwordx4 v4, v[76:79], s[36:37] offset:3072
    s_mov_b64 exec, -1
    v_mov_b32 v80, v21
    v_mov_b32 v81, v33
    v_mov_b32 v82, v45
    v_mov_b32 v83, v57
    s_cmp_eq_u32 s60, 4
    s_cselect_b64 exec, s[62:63], -1
    global_store_dwordx4 v5, v[80:83], s[36:37] offset:0
    s_mov_b64 exec, -1
    v_mov_b32 v84, v22
    v_mov_b32 v85, v34
    v_mov_b32 v86, v46
    v_mov_b32 v87, v58
    s_cmp_eq_u32 s60, 5
    s_cselect_b64 exec, s[62:63], -1
    global_store_dwordx4 v5, v[84:87], s[36:37] offset:1024
    s_mov_b64 exec, -1
    v_mov_b32 v88, v24
    v_mov_b32 v89, v36
    v_mov_b32 v90, v48
    v_mov_b32 v91, v60
    s_cmp_eq_u32 s60, 6
    s_cselect_b64 exec, s[62:63], -1
    global_store_dwordx4 v5, v[88:91], s[36:37] offset:2048
    s_mov_b64 exec, -1
    v_mov_b32 v92, v25
    v_mov_b32 v93, v37
    v_mov_b32 v94, v49
    v_mov_b32 v95, v61
    s_cmp_eq_u32 s60, 7
    s_cselect_b64 exec, s[62:63], -1
    global_store_dwordx4 v5, v[92:95], s[36:37] offset:3072
    s_mov_b64 exec, -1
    s_endpgm
L_moe:
    s_setprio 3
    s_mov_b32 s88, 0x400000
    s_mov_b32 s52, 0xffff0000
    s_lshr_b32 s50, s3, 3
    s_and_b32 s51, s3, 7
    v_and_b32 v4, 15, v1
    v_lshrrev_b32 v5, 4, v1
    s_mul_i32 s7, s51, 229376
    s_lshl_b32 s53, s50, 7
    s_add_u32 s7, s7, s53
    v_lshl_add_u32 v6, v4, 3, s7
    s_movk_i32 s53, 28672
    v_mad_u32_u24 v6, v5, s53, v6
    s_lshl_b32 s7, s50, 16
    s_lshl_b32 s53, s51, 7
    s_add_u32 s7, s7, s53
    v_lshl_add_u32 v7, v4, 3, s7
    v_lshl_add_u32 v7, v5, 13, v7
    s_mov_b32 s44, s30
    s_mov_b32 s45, s31
    s_mov_b32 s46, 1835008
    s_mov_b32 s47, 0x00020000
    s_mov_b32 s56, s32
    s_mov_b32 s57, s33
    s_mov_b32 s58, 1835008
    s_mov_b32 s59, 0x00020000
    s_mov_b32 s60, s34
    s_mov_b32 s61, s35
    s_mov_b32 s62, 1835008
    s_mov_b32 s63, 0x00020000
    v_lshlrev_b32 v8, 4, v1
    v_add_u32 v8, 16384, v8
    s_lshr_b32 s7, s2, 3
    s_lshl_b32 s7, s7, 9
    s_add_u32 s7, s7, 4096
    v_and_b32 v9, 3, v1
    v_lshl_add_u32 v9, v9, 7, s7
    s_waitcnt lgkmcnt(0)
    s_mul_i32 s5, s6, 0x9E3779B1
    s_add_u32 s5, s5, 0x7F4A7C15
    s_mov_b64 exec, 1
    v_mov_b32 v13, 16
    ds_add_u32 v160, v13 offset:16
    s_mov_b64 exec, -1
    s_mov_b32 s92, 0x05040100
    s_mov_b32 s93, 0x07060302
    s_lshl_b32 s7, s3, 10
    s_add_u32 s7, s7, 32768
    v_lshl_add_u32 v161, v1, 4, s7
    s_lshl_b32 s7, s50, 13
    s_add_u32 s7, s7, 32768
    v_lshl_add_u32 v14, v1, 4, s7
    v_add_u32 v15, 4096, v14
    v_lshlrev_b32 v162, 1, v1
    v_add_u32 v162, 118528, v162
    v_lshl_add_u32 v163, v4, 2, v5
    v_lshlrev_b32 v163, 1, v163
    v_add_u32 v163, 118400, v163
    v_lshlrev_b32 v164, 4, v5
    v_add_u32 v164, 118400, v164
    s_lshl_b32 s7, s3, 9
    s_add_u32 s7, s7, 262144
    v_lshl_add_u32 v165, v4, 1, v5
    v_lshl_add_u32 v165, v165, 4, s7
    s_lshr_b32 s7, s3, 5
    s_lshl_b32 s7, s7, 9
    s_and_b32 s53, s3, 31
    s_lshl_b32 s53, s53, 4
    s_add_u32 s7, s7, s53
    s_add_u32 s7, s7, 262144
    v_lshl_add_u32 v166, v1, 12, s7
    s_lshl_b32 s7, s51, 7
    v_lshl_add_u32 v167, v1, 1, s7
    s_lshl_b32 s7, s2, 4
    s_add_u32 s7, s7, 4096
    v_lshl_add_u32 v144, v1, 12, s7
    s_mov_b64 s[42:43], 8
    v_mul_u32_u24 v145, 12, v1
    v_min_u32 v145, 24, v145
    v_add_u32 v145, 118272, v145
    v_mov_b32 v146, 118360
    v_cndmask_b32 v145, v145, v146, s[42:43]
    v_mov_b32 v151, s5
    s_cmp_ge_u32 s3, 224
    s_cbranch_scc1 L_no_we
    s_sleep 12
    s_mov_b32 s53, 0
    buffer_load_dwordx2 v[16:17], v6, s[44:47], s53 offen nt
    buffer_load_dwordx2 v[32:33], v6, s[56:59], s53 offen nt
    s_mov_b32 s53, 3584
    buffer_load_dwordx2 v[18:19], v6, s[44:47], s53 offen nt
    buffer_load_dwordx2 v[34:35], v6, s[56:59], s53 offen nt
    s_mov_b32 s53, 7168
    buffer_load_dwordx2 v[20:21], v6, s[44:47], s53 offen nt
    buffer_load_dwordx2 v[36:37], v6, s[56:59], s53 offen nt
    s_mov_b32 s53, 10752
    buffer_load_dwordx2 v[22:23], v6, s[44:47], s53 offen nt
    buffer_load_dwordx2 v[38:39], v6, s[56:59], s53 offen nt
    s_mov_b32 s53, 14336
    buffer_load_dwordx2 v[24:25], v6, s[44:47], s53 offen nt
    buffer_load_dwordx2 v[40:41], v6, s[56:59], s53 offen nt
    s_mov_b32 s53, 17920
    buffer_load_dwordx2 v[26:27], v6, s[44:47], s53 offen nt
    buffer_load_dwordx2 v[42:43], v6, s[56:59], s53 offen nt
    s_mov_b32 s53, 21504
    buffer_load_dwordx2 v[28:29], v6, s[44:47], s53 offen nt
    buffer_load_dwordx2 v[44:45], v6, s[56:59], s53 offen nt
    s_mov_b32 s53, 25088
    buffer_load_dwordx2 v[30:31], v6, s[44:47], s53 offen nt
    buffer_load_dwordx2 v[46:47], v6, s[56:59], s53 offen nt
L_no_we:
L_pub_wait:
    ds_read_b32 v13, v160 offset:16
    s_sub_u32 s88, s88, 1
    s_cbranch_scc1 L_exit
    s_waitcnt lgkmcnt(0)
    v_readfirstlane_b32 s7, v13
    s_and_b32 s7, s7, 63
    s_cmp_eq_u32 s7, 40
    s_cbranch_scc0 L_pub_wait
    ds_read2_b32 v[148:149], v145 offset0:0 offset1:1
    ds_read_b32 v150, v145 offset:8
    s_waitcnt lgkmcnt(0)
    s_mov_b64 exec, 15
    global_store_dwordx4 v144, v[148:151], s[40:41] sc1
    s_mov_b64 exec, -1
    s_cmp_ge_u32 s3, 224
    s_cbranch_scc0 L_moe_has_w
L_lnw_16:
    s_sleep 1
    ds_read_b32 v13, v160 offset:16
    s_sub_u32 s88, s88, 1
    s_cbranch_scc1 L_exit
    s_waitcnt lgkmcnt(0)
    v_readfirstlane_b32 s7, v13
    s_and_b32 s7, s7, 65535
    s_cmp_ge_u32 s7, 1128
    s_cbranch_scc0 L_lnw_16
    global_load_dwordx4 v[128:131], v8, s[40:41] offset:0 sc1
    global_load_dwordx4 v[132:135], v8, s[40:41] offset:1024 sc1
    global_load_dwordx4 v[136:139], v8, s[40:41] offset:2048 sc1
    global_load_dwordx4 v[140:143], v8, s[40:41] offset:3072 sc1
    s_waitcnt vmcnt(0)
    s_branch L_key_check
L_moe_has_w:
L_lnw_17:
    s_sleep 1
    ds_read_b32 v13, v160 offset:16
    s_sub_u32 s88, s88, 1
    s_cbranch_scc1 L_exit
    s_waitcnt lgkmcnt(0)
    v_readfirstlane_b32 s7, v13
    s_and_b32 s7, s7, 255
    s_cmp_ge_u32 s7, 104
    s_cbranch_scc0 L_lnw_17
    s_mov_b32 s53, 114688
    buffer_load_dwordx2 v[48:49], v6, s[44:47], s53 offen nt
    buffer_load_dwordx2 v[64:65], v6, s[56:59], s53 offen nt
    s_mov_b32 s53, 118272
    buffer_load_dwordx2 v[50:51], v6, s[44:47], s53 offen nt
    buffer_load_dwordx2 v[66:67], v6, s[56:59], s53 offen nt
    s_mov_b32 s53, 121856
    buffer_load_dwordx2 v[52:53], v6, s[44:47], s53 offen nt
    buffer_load_dwordx2 v[68:69], v6, s[56:59], s53 offen nt
    s_mov_b32 s53, 125440
    buffer_load_dwordx2 v[54:55], v6, s[44:47], s53 offen nt
    buffer_load_dwordx2 v[70:71], v6, s[56:59], s53 offen nt
    s_mov_b32 s53, 129024
    buffer_load_dwordx2 v[56:57], v6, s[44:47], s53 offen nt
    buffer_load_dwordx2 v[72:73], v6, s[56:59], s53 offen nt
    s_mov_b32 s53, 132608
    buffer_load_dwordx2 v[58:59], v6, s[44:47], s53 offen nt
    buffer_load_dwordx2 v[74:75], v6, s[56:59], s53 offen nt
    s_mov_b32 s53, 136192
    buffer_load_dwordx2 v[60:61], v6, s[44:47], s53 offen nt
    buffer_load_dwordx2 v[76:77], v6, s[56:59], s53 offen nt
    s_mov_b32 s53, 139776
    buffer_load_dwordx2 v[62:63], v6, s[44:47], s53 offen nt
    buffer_load_dwordx2 v[78:79], v6, s[56:59], s53 offen nt
L_lnw_18:
    s_sleep 1
    ds_read_b32 v13, v160 offset:16
    s_sub_u32 s88, s88, 1
    s_cbranch_scc1 L_exit
    s_waitcnt lgkmcnt(0)
    v_readfirstlane_b32 s7, v13
    s_and_b32 s7, s7, 65535
    s_cmp_ge_u32 s7, 1128
    s_cbranch_scc0 L_lnw_18
    global_load_dwordx4 v[128:131], v8, s[40:41] offset:0 sc1
    global_load_dwordx4 v[132:135], v8, s[40:41] offset:1024 sc1
    global_load_dwordx4 v[136:139], v8, s[40:41] offset:2048 sc1
    global_load_dwordx4 v[140:143], v8, s[40:41] offset:3072 sc1
    s_waitcnt vmcnt(20)
    v_perm_b32 v112, v18, v16, s92
    v_perm_b32 v116, v18, v16, s93
    v_perm_b32 v120, v19, v17, s92
    v_perm_b32 v124, v19, v17, s93
    v_perm_b32 v113, v22, v20, s92
    v_perm_b32 v117, v22, v20, s93
    v_perm_b32 v121, v23, v21, s92
    v_perm_b32 v125, v23, v21, s93
    v_perm_b32 v114, v26, v24, s92
    v_perm_b32 v118, v26, v24, s93
    v_perm_b32 v122, v27, v25, s92
    v_perm_b32 v126, v27, v25, s93
    v_perm_b32 v115, v30, v28, s92
    v_perm_b32 v119, v30, v28, s93
    v_perm_b32 v123, v31, v29, s92
    v_perm_b32 v127, v31, v29, s93
    v_perm_b32 v16, v34, v32, s92
    v_perm_b32 v20, v34, v32, s93
    v_perm_b32 v24, v35, v33, s92
    v_perm_b32 v28, v35, v33, s93
    v_perm_b32 v17, v38, v36, s92
    v_perm_b32 v21, v38, v36, s93
    v_perm_b32 v25, v39, v37, s92
    v_perm_b32 v29, v39, v37, s93
    v_perm_b32 v18, v42, v40, s92
    v_perm_b32 v22, v42, v40, s93
    v_perm_b32 v26, v43, v41, s92
    v_perm_b32 v30, v43, v41, s93
    v_perm_b32 v19, v46, v44, s92
    v_perm_b32 v23, v46, v44, s93
    v_perm_b32 v27, v47, v45, s92
    v_perm_b32 v31, v47, v45, s93
    s_waitcnt vmcnt(4)
    v_perm_b32 v32, v50, v48, s92
    v_perm_b32 v36, v50, v48, s93
    v_perm_b32 v40, v51, v49, s92
    v_perm_b32 v44, v51, v49, s93
    v_perm_b32 v33, v54, v52, s92
    v_perm_b32 v37, v54, v52, s93
    v_perm_b32 v41, v55, v53, s92
    v_perm_b32 v45, v55, v53, s93
    v_perm_b32 v34, v58, v56, s92
    v_perm_b32 v38, v58, v56, s93
    v_perm_b32 v42, v59, v57, s92
    v_perm_b32 v46, v59, v57, s93
    v_perm_b32 v35, v62, v60, s92
    v_perm_b32 v39, v62, v60, s93
    v_perm_b32 v43, v63, v61, s92
    v_perm_b32 v47, v63, v61, s93
    v_perm_b32 v48, v66, v64, s92
    v_perm_b32 v52, v66, v64, s93
    v_perm_b32 v56, v67, v65, s92
    v_perm_b32 v60, v67, v65, s93
    v_perm_b32 v49, v70, v68, s92
    v_perm_b32 v53, v70, v68, s93
    v_perm_b32 v57, v71, v69, s92
    v_perm_b32 v61, v71, v69, s93
    v_perm_b32 v50, v74, v72, s92
    v_perm_b32 v54, v74, v72, s93
    v_perm_b32 v58, v75, v73, s92
    v_perm_b32 v62, v75, v73, s93
    v_perm_b32 v51, v78, v76, s92
    v_perm_b32 v55, v78, v76, s93
    v_perm_b32 v59, v79, v77, s92
    v_perm_b32 v63, v79, v77, s93
    s_setprio 3
    s_waitcnt vmcnt(0)
L_key_check:
L_ws_19:
    ds_read_b32 v13, v160
    s_sub_u32 s88, s88, 1
    s_cbranch_scc1 L_exit
    s_waitcnt lgkmcnt(0)
    v_readfirstlane_b32 s7, v13
    s_and_b32 s7, s7, 66846720
    s_cmp_eq_u32 s7, 66846720
    s_cbranch_scc0 L_ws_19
    s_mov_b32 s53, 0
L_key_loop:
    v_cmp_ne_u32 vcc, s5, v131
    v_cmp_ne_u32 s[42:43], s5, v135
    s_or_b64 vcc, vcc, s[42:43]
    v_cmp_ne_u32 s[42:43], s5, v139
    s_or_b64 vcc, vcc, s[42:43]
    v_cmp_ne_u32 s[42:43], s5, v143
    s_or_b64 vcc, vcc, s[42:43]
    s_and_b64 exec, exec, vcc
    s_cbranch_execz L_key_done
    s_sleep 1
    global_load_dwordx4 v[128:131], v8, s[40:41] offset:0 sc1
    global_load_dwordx4 v[132:135], v8, s[40:41] offset:1024 sc1
    global_load_dwordx4 v[136:139], v8, s[40:41] offset:2048 sc1
    global_load_dwordx4 v[140:143], v8, s[40:41] offset:3072 sc1
    s_add_u32 s53, s53, 1
    s_cmp_lt_u32 s53, 65536
    s_waitcnt vmcnt(0)
    s_cbranch_scc1 L_key_loop
L_key_done:
    s_mov_b64 exec, -1
    v_max3_u32 v2, v129, v133, v137
    v_max_u32 v2, v2, v141
    s_nop 1
    v_max_u32_dpp v2, v2, v2 row_shr:1 row_mask:0xf bank_mask:0xf
    s_nop 1
    v_max_u32_dpp v2, v2, v2 row_shr:2 row_mask:0xf bank_mask:0xf
    s_nop 1
    v_max_u32_dpp v2, v2, v2 row_shr:4 row_mask:0xf bank_mask:0xf
    s_nop 1
    v_max_u32_dpp v2, v2, v2 row_shr:8 row_mask:0xf bank_mask:0xf
    s_nop 1
    v_max_u32_dpp v2, v2, v2 row_bcast:15 row_mask:0xa bank_mask:0xf
    s_nop 1
    v_max_u32_dpp v2, v2, v2 row_bcast:31 row_mask:0xc bank_mask:0xf
    v_mov_b32 v9, 0
    v_readlane_b32 s54, v2, 63
    s_and_b32 s55, s54, 0xffff
    s_sub_u32 s55, 2047, s55
    s_and_b32 s55, s55, 2047
    s_lshl_b32 s7, s55, 10
    v_add_u32 v3, s7, v167
    global_load_short_d16_hi v9, v3, s[8:9]
    v_mov_b32 v10, s55
    v_mov_b32 v11, 65536
    s_mov_b64 exec, 1
    ds_write_b32 v160, v10 offset:4
    ds_or_b32 v160, v11
    s_mov_b64 exec, -1
    s_cmp_ge_u32 s3, 224
    s_cbranch_scc1 L_no_down
    s_mov_b32 s53, 0
    buffer_load_dwordx2 v[80:81], v7, s[60:63], s53 offen offset:0 nt
    buffer_load_dwordx2 v[82:83], v7, s[60:63], s53 offen offset:1024 nt
    buffer_load_dwordx2 v[84:85], v7, s[60:63], s53 offen offset:2048 nt
    buffer_load_dwordx2 v[86:87], v7, s[60:63], s53 offen offset:3072 nt
    s_mov_b32 s53, 4096
    buffer_load_dwordx2 v[88:89], v7, s[60:63], s53 offen offset:0 nt
    buffer_load_dwordx2 v[90:91], v7, s[60:63], s53 offen offset:1024 nt
    buffer_load_dwordx2 v[92:93], v7, s[60:63], s53 offen offset:2048 nt
    buffer_load_dwordx2 v[94:95], v7, s[60:63], s53 offen offset:3072 nt
    s_mov_b32 s53, 32768
    buffer_load_dwordx2 v[96:97], v7, s[60:63], s53 offen offset:0 nt
    buffer_load_dwordx2 v[98:99], v7, s[60:63], s53 offen offset:1024 nt
    buffer_load_dwordx2 v[100:101], v7, s[60:63], s53 offen offset:2048 nt
    buffer_load_dwordx2 v[102:103], v7, s[60:63], s53 offen offset:3072 nt
    s_mov_b32 s53, 36864
    buffer_load_dwordx2 v[104:105], v7, s[60:63], s53 offen offset:0 nt
    buffer_load_dwordx2 v[106:107], v7, s[60:63], s53 offen offset:1024 nt
    buffer_load_dwordx2 v[108:109], v7, s[60:63], s53 offen offset:2048 nt
    buffer_load_dwordx2 v[110:111], v7, s[60:63], s53 offen offset:3072 nt
L_no_down:
    v_cmp_eq_u32 vcc, s54, v133
    v_cmp_eq_u32 s[42:43], s54, v137
    v_cmp_eq_u32 s[44:45], s54, v141
    v_cmp_eq_u32 s[46:47], s54, v129
    v_cndmask_b32 v128, v128, v132, vcc
    v_cndmask_b32 v128, v128, v136, s[42:43]
    v_cndmask_b32 v128, v128, v140, s[44:45]
    s_or_b64 vcc, vcc, s[42:43]
    s_or_b64 s[44:45], s[44:45], s[46:47]
    s_or_b64 vcc, vcc, s[44:45]
    s_ff1_i32_b64 s7, vcc
    s_and_b32 s7, s7, 63
    v_readlane_b32 s89, v128, s7
    s_and_b32 s7, s54, s52
    s_not_b32 s42, s7
    s_and_b32 s42, s42, s52
    s_xor_b32 s43, s7, 0x80000000
    s_bitcmp1_b32 s7, 31
    s_cselect_b32 s7, s43, s42
    v_mov_b32 v12, s7
    v_mul_f32 v12, 0xbfb8aa3b, v12
    v_exp_f32 v12, v12
    s_nop 0
    v_add_f32 v12, 1.0, v12
    v_rcp_f32 v12, v12
    s_nop 0
    v_cvt_pk_bf16_f32 v12, v12, v12
    v_and_b32 v12, s52, v12
    s_and_b32 s90, s89, s52
    s_lshl_b32 s89, s89, 16
    v_rcp_f32 v13, s90
    s_mov_b32 s42, 0xffff0000
    s_mov_b32 s43, 0xffff0000
    s_mov_b32 s44, 0
    s_mov_b32 s45, -1
    s_cmp_ge_u32 s3, 224
    s_cbranch_scc1 L_moe_idle
    v_mov_b32 v74, 0
    v_mov_b32 v75, s5
    s_waitcnt vmcnt(16)
    v_subrev_f32 v9, s89, v9
    v_mul_f32 v9, v9, v13
    v_cvt_pk_bf16_f32 v9, v9, v9
    ds_write_b16 v162, v9
    ds_read_b128 v[64:67], v164 offset:128
    ds_read_b128 v[68:71], v164 offset:192
    s_waitcnt lgkmcnt(0)
    v_mfma_f32_16x16x32_bf16 v[128:131], v[64:67], v[112:115], 0
    v_mfma_f32_16x16x32_bf16 v[132:135], v[64:67], v[116:119], 0
    v_mfma_f32_16x16x32_bf16 v[136:139], v[64:67], v[120:123], 0
    v_mfma_f32_16x16x32_bf16 v[140:143], v[64:67], v[124:127], 0
    v_mfma_f32_16x16x32_bf16 v[128:131], v[68:71], v[32:35], v[128:131]
    v_mfma_f32_16x16x32_bf16 v[132:135], v[68:71], v[36:39], v[132:135]
    v_mfma_f32_16x16x32_bf16 v[136:139], v[68:71], v[40:43], v[136:139]
    v_mfma_f32_16x16x32_bf16 v[140:143], v[68:71], v[44:47], v[140:143]
    v_mfma_f32_16x16x32_bf16 v[144:147], v[64:67], v[16:19], 0
    v_mfma_f32_16x16x32_bf16 v[148:151], v[64:67], v[20:23], 0
    v_mfma_f32_16x16x32_bf16 v[152:155], v[64:67], v[24:27], 0
    v_mfma_f32_16x16x32_bf16 v[156:159], v[64:67], v[28:31], 0
    v_mfma_f32_16x16x32_bf16 v[144:147], v[68:71], v[48:51], v[144:147]
    v_mfma_f32_16x16x32_bf16 v[148:151], v[68:71], v[52:55], v[148:151]
    v_mfma_f32_16x16x32_bf16 v[152:155], v[68:71], v[56:59], v[152:155]
    v_mfma_f32_16x16x32_bf16 v[156:159], v[68:71], v[60:63], v[156:159]
    v_cndmask_b32 v128, v128, v132, s[42:43]
    v_cndmask_b32 v136, v136, v140, s[42:43]
    v_cndmask_b32 v72, v128, v136, s[44:45]
    s_nop 2
    v_cndmask_b32 v144, v144, v148, s[42:43]
    s_nop 0
    v_cndmask_b32 v152, v152, v156, s[42:43]
    v_cndmask_b32 v73, v144, v152, s[44:45]
    global_store_dwordx4 v161, v[72:75], s[40:41] sc1
    s_waitcnt vmcnt(0)
    v_perm_b32 v16, v82, v80, s92
    v_perm_b32 v20, v82, v80, s93
    v_perm_b32 v24, v83, v81, s92
    v_perm_b32 v28, v83, v81, s93
    v_perm_b32 v17, v86, v84, s92
    v_perm_b32 v21, v86, v84, s93
    v_perm_b32 v25, v87, v85, s92
    v_perm_b32 v29, v87, v85, s93
    v_perm_b32 v18, v90, v88, s92
    v_perm_b32 v22, v90, v88, s93
    v_perm_b32 v26, v91, v89, s92
    v_perm_b32 v30, v91, v89, s93
    v_perm_b32 v19, v94, v92, s92
    v_perm_b32 v23, v94, v92, s93
    v_perm_b32 v27, v95, v93, s92
    v_perm_b32 v31, v95, v93, s93
    v_perm_b32 v32, v98, v96, s92
    v_perm_b32 v36, v98, v96, s93
    v_perm_b32 v40, v99, v97, s92
    v_perm_b32 v44, v99, v97, s93
    v_perm_b32 v33, v102, v100, s92
    v_perm_b32 v37, v102, v100, s93
    v_perm_b32 v41, v103, v101, s92
    v_perm_b32 v45, v103, v101, s93
    v_perm_b32 v34, v106, v104, s92
    v_perm_b32 v38, v106, v104, s93
    v_perm_b32 v42, v107, v105, s92
    v_perm_b32 v46, v107, v105, s93
    v_perm_b32 v35, v110, v108, s92
    v_perm_b32 v39, v110, v108, s93
    v_perm_b32 v43, v111, v109, s92
    v_perm_b32 v47, v111, v109, s93
    s_sleep 2
    s_mov_b32 s53, 0
L_hopa_loop:
    global_load_dwordx4 v[128:131], v14, s[40:41] offset:0 sc1
    global_load_dwordx4 v[132:135], v14, s[40:41] offset:1024 sc1
    global_load_dwordx4 v[136:139], v14, s[40:41] offset:2048 sc1
    global_load_dwordx4 v[140:143], v14, s[40:41] offset:3072 sc1
    global_load_dwordx4 v[144:147], v15, s[40:41] offset:0 sc1
    global_load_dwordx4 v[148:151], v15, s[40:41] offset:1024 sc1
    global_load_dwordx4 v[152:155], v15, s[40:41] offset:2048 sc1
    global_load_dwordx4 v[156:159], v15, s[40:41] offset:3072 sc1
    s_add_u32 s53, s53, 1
    s_waitcnt vmcnt(0)
    v_cmp_ne_u32 vcc, s5, v131
    v_cmp_ne_u32 s[56:57], s5, v135
    s_or_b64 vcc, vcc, s[56:57]
    v_cmp_ne_u32 s[56:57], s5, v139
    s_or_b64 vcc, vcc, s[56:57]
    v_cmp_ne_u32 s[56:57], s5, v143
    s_or_b64 vcc, vcc, s[56:57]
    v_cmp_ne_u32 s[56:57], s5, v147
    s_or_b64 vcc, vcc, s[56:57]
    v_cmp_ne_u32 s[56:57], s5, v151
    s_or_b64 vcc, vcc, s[56:57]
    v_cmp_ne_u32 s[56:57], s5, v155
    s_or_b64 vcc, vcc, s[56:57]
    v_cmp_ne_u32 s[56:57], s5, v159
    s_or_b64 vcc, vcc, s[56:57]
    s_and_b64 exec, exec, vcc
    s_cbranch_execz L_hopa_done
    s_sleep 2
    s_cmp_lt_u32 s53, 65536
    s_cbranch_scc1 L_hopa_loop
L_hopa_done:
    s_mov_b64 exec, -1
    v_pk_add_f32 v[128:129], v[128:129], v[132:133]
    v_pk_add_f32 v[136:137], v[136:137], v[140:141]
    v_pk_add_f32 v[144:145], v[144:145], v[148:149]
    v_pk_add_f32 v[152:153], v[152:153], v[156:157]
    v_pk_add_f32 v[128:129], v[128:129], v[136:137]
    v_pk_add_f32 v[144:145], v[144:145], v[152:153]
    v_pk_add_f32 v[128:129], v[128:129], v[144:145]
    v_cvt_pk_bf16_f32 v2, v128, v129
    v_lshlrev_b32 v3, 16, v2
    v_and_b32 v2, s52, v2
    v_mul_f32 v10, 0xbfb8aa3b, v3
    v_exp_f32 v10, v10
    s_nop 0
    v_add_f32 v10, 1.0, v10
    v_rcp_f32 v10, v10
    s_nop 0
    v_mul_f32 v10, v3, v10
    v_cvt_pk_bf16_f32 v10, v10, v10
    v_and_b32 v10, s52, v10
    v_mul_f32 v10, v10, v2
    v_cvt_pk_bf16_f32 v10, v10, v10
    ds_write_b16 v163, v10
    ds_read_b128 v[64:67], v164
    ds_read_b128 v[68:71], v164 offset:64
    s_waitcnt lgkmcnt(0)
    v_mfma_f32_16x16x32_bf16 v[128:131], v[64:67], v[16:19], 0
    v_mfma_f32_16x16x32_bf16 v[132:135], v[64:67], v[20:23], 0
    v_mfma_f32_16x16x32_bf16 v[136:139], v[64:67], v[24:27], 0
    v_mfma_f32_16x16x32_bf16 v[140:143], v[64:67], v[28:31], 0
    v_mfma_f32_16x16x32_bf16 v[128:131], v[68:71], v[32:35], v[128:131]
    v_mfma_f32_16x16x32_bf16 v[132:135], v[68:71], v[36:39], v[132:135]
    v_mfma_f32_16x16x32_bf16 v[136:139], v[68:71], v[40:43], v[136:139]
    v_mfma_f32_16x16x32_bf16 v[140:143], v[68:71], v[44:47], v[140:143]
    s_nop 6
    v_cndmask_b32 v72, v128, v136, s[42:43]
    v_cndmask_b32 v73, v132, v140, s[42:43]
    s_mov_b32 exec_hi, 0
    global_store_dwordx4 v165, v[72:75], s[40:41] sc1
    s_mov_b64 exec, -1
    s_sleep 21
    s_branch L_moe_final
L_moe_idle:
    s_sleep 70
L_moe_final:
    v_mov_b32 v128, 0
    v_mov_b32 v129, 0
    s_mov_b32 s53, 0
    s_mov_b64 exec, 0xfffffff
L_hopb_loop:
    global_load_dwordx4 v[128:131], v166, s[40:41] sc1
    s_add_u32 s53, s53, 1
    s_waitcnt vmcnt(0)
    v_cmp_ne_u32 vcc, s5, v131
    s_and_b64 exec, exec, vcc
    s_cbranch_execz L_hopb_done
    s_sleep 2
    s_cmp_lt_u32 s53, 65536
    s_cbranch_scc1 L_hopb_loop
L_hopb_done:
    s_mov_b64 exec, -1
    v_add_f32_dpp v128, v128, v128 row_shr:1 row_mask:0xf bank_mask:0xf
    v_add_f32_dpp v129, v129, v129 row_shr:1 row_mask:0xf bank_mask:0xf
    s_nop 0
    v_add_f32_dpp v128, v128, v128 row_shr:2 row_mask:0xf bank_mask:0xf
    v_add_f32_dpp v129, v129, v129 row_shr:2 row_mask:0xf bank_mask:0xf
    s_nop 0
    v_add_f32_dpp v128, v128, v128 row_shr:4 row_mask:0xf bank_mask:0xf
    v_add_f32_dpp v129, v129, v129 row_shr:4 row_mask:0xf bank_mask:0xf
    s_nop 0
    v_add_f32_dpp v128, v128, v128 row_shr:8 row_mask:0xf bank_mask:0xf
    v_add_f32_dpp v129, v129, v129 row_shr:8 row_mask:0xf bank_mask:0xf
    s_nop 0
    v_add_f32_dpp v128, v128, v128 row_bcast:15 row_mask:0xa bank_mask:0xf
    v_add_f32_dpp v129, v129, v129 row_bcast:15 row_mask:0xa bank_mask:0xf
    s_nop 0
    v_add_f32_dpp v128, v128, v128 row_bcast:31 row_mask:0xc bank_mask:0xf
    v_add_f32_dpp v129, v129, v129 row_bcast:31 row_mask:0xc bank_mask:0xf
    v_readlane_b32 s42, v128, 63
    v_readlane_b32 s43, v129, 63
    s_nop 1
    v_mov_b32 v3, s43
    v_cvt_pk_bf16_f32 v2, s42, v3
    v_and_b32 v3, s52, v2
    v_lshlrev_b32 v2, 16, v2
    v_pk_mul_f32 v[2:3], v[2:3], v[12:13] op_sel_hi:[1,0]
    v_cvt_pk_bf16_f32 v2, v2, v3
    v_and_b32 v3, s52, v2
    v_lshlrev_b32 v2, 16, v2
    s_lshl_b32 s42, s55, 10
    s_lshl_b32 s43, s3, 2
    s_add_u32 s42, s42, s43
    v_mov_b32 v9, s42
L_ws_20:
    ds_read_b32 v10, v160
    s_sub_u32 s88, s88, 1
    s_cbranch_scc1 L_exit
    s_waitcnt lgkmcnt(0)
    v_readfirstlane_b32 s7, v10
    s_and_b32 s7, s7, 131072
    s_cmp_eq_u32 s7, 131072
    s_cbranch_scc0 L_ws_20
    ds_read_b64 v[4:5], v160 offset:8
    s_waitcnt lgkmcnt(0)
    v_pk_add_f32 v[2:3], v[2:3], v[4:5]
    v_cvt_pk_bf16_f32 v2, v2, v3
    s_mov_b64 exec, 1
    global_store_dword v9, v2, s[36:37]
    s_cmp_eq_u32 s2, 0
    s_cbranch_scc0 L_no_epoch
    s_add_u32 s7, s6, 1
    v_mov_b32 v10, 0
    v_mov_b32 v11, s7
    global_store_dword v10, v11, s[40:41] sc1
L_no_epoch:
    s_mov_b64 exec, -1
    s_endpgm
L_exit:
    s_endpgm
L_end:
.section .rodata,"a"
.p2align 6
.amdhsa_kernel parallel_sum__ssm_conv_s4__moe_arch_mod__prompt_kernel
  .amdhsa_next_free_vgpr 168
  .amdhsa_next_free_sgpr 100
  .amdhsa_accum_offset 168
  .amdhsa_group_segment_fixed_size 0
  .amdhsa_kernarg_size 136
  .amdhsa_user_sgpr_count 2
  .amdhsa_user_sgpr_kernarg_segment_ptr 1
  .amdhsa_system_sgpr_workgroup_id_x 1
.end_amdhsa_kernel
```
